```python
import torch

def _softmax(x, axis=-1):
    return torch.softmax(x, dim=axis)
def _gelu(x):
    return torch.nn.functional.gelu(x, approximate="tanh")
def _silu(x):
    return torch.nn.functional.silu(x)
def _sigmoid(x):
    return torch.sigmoid(x)
def _layernorm(x, axis=-1, eps=1e-5):
    m = x.mean(dim=axis, keepdim=True)
    v = x.var(dim=axis, keepdim=True, unbiased=False)
    return (x - m) / torch.sqrt(v + eps)
def _scatter_add(tgt, idx, src, axis=0):
    return tgt.clone().index_add_(axis, idx, src)
def _segment_sum(src, seg, n):
    out = torch.zeros((n,) + src.shape[1:], dtype=src.dtype)
    return out.index_add_(0, seg, src)
def _pad(x, pw):
    flat = tuple(v for pair in reversed(pw) for v in pair)
    return torch.nn.functional.pad(x, flat)

kernel_name = 'recurrent_scan__ssm_conv_s4__mixer_s_mlp__prompt'

def setup_inputs():

    _w = (lambda a: (lambda t: t.to(torch.bfloat16) if t.is_floating_point() else t)(torch.as_tensor(a)))
    def _A_setup():
        B, L, D, N = 1, 2048, 512, 128
        A_re = -(lambda _x: torch.exp(torch.as_tensor(_x)))((lambda *s: torch.randn(*s, dtype=torch.bfloat16) * 3.2)(D, N))
        A_im = torch.pi * (lambda *s: torch.randn(*s, dtype=torch.bfloat16) * 0.05)(D, N)
        B_re = (lambda *s: torch.randn(*s, dtype=torch.bfloat16) * 0.1)(D, N)
        B_im = (lambda *s: torch.randn(*s, dtype=torch.bfloat16) * 0.1)(D, N)
        C_re = (lambda *s: torch.randn(*s, dtype=torch.bfloat16) * 0.1)(D, N)
        C_im = (lambda *s: torch.randn(*s, dtype=torch.bfloat16) * 0.1)(D, N)
        log_dt = (lambda *s: torch.randn(*s, dtype=torch.bfloat16) * 0.05)(D) * 0.5 - 4.0
        Dskip = (lambda *s: torch.randn(*s, dtype=torch.bfloat16) * 0.05)(D)
        return {
            "u": _w((lambda *s: torch.randn(*s, dtype=torch.bfloat16) * 0.05)(B, L, D)),
            "A_re": _w(A_re),
            "A_im": _w(A_im),
            "B_re": _w(B_re),
            "B_im": _w(B_im),
            "C_re": _w(C_re),
            "C_im": _w(C_im),
            "log_dt": _w(log_dt),
            "Dskip": _w(Dskip),
        }
    _A_in = _A_setup()

    def _B_setup():
        B, S, D, F = 1, 2048, 512, 1376
        return {
            "x":  _w((lambda *s: torch.randn(*s, dtype=torch.bfloat16) * 0.05)(B, S, D)),
            "w1": _w((lambda *s: torch.randn(*s, dtype=torch.bfloat16) * 3.2)(D, D) * (D ** -0.5)),
            "w2": _w((lambda *s: torch.randn(*s, dtype=torch.bfloat16) * 3.2)(D, D) * (D ** -0.5)),
            "w3": _w((lambda *s: torch.randn(*s, dtype=torch.bfloat16) * 3.2)(D, F) * (D ** -0.5)),
            "w4": _w((lambda *s: torch.randn(*s, dtype=torch.bfloat16) * 1.6)(F, D) * (F ** -0.5)),
        }
    _B_in = _B_setup()

    return {
        "A_u": _A_in["u"],
        "A_A_re": _A_in["A_re"],
        "A_A_im": _A_in["A_im"],
        "A_B_re": _A_in["B_re"],
        "A_B_im": _A_in["B_im"],
        "A_C_re": _A_in["C_re"],
        "A_C_im": _A_in["C_im"],
        "A_log_dt": _A_in["log_dt"],
        "A_Dskip": _A_in["Dskip"],
        "B_x": _B_in["x"],
        "B_w1": _B_in["w1"],
        "B_w2": _B_in["w2"],
        "B_w3": _B_in["w3"],
        "B_w4": _B_in["w4"],
    }

def reference(A_u, A_A_re, A_A_im, A_B_re, A_B_im, A_C_re, A_C_im, A_log_dt, A_Dskip, B_x, B_w1, B_w2, B_w3, B_w4):
    def _A_ref(u, A_re, A_im, B_re, B_im, C_re, C_im, log_dt, Dskip):
        Bsz, L, D = u.shape
        dt = torch.exp(log_dt)[:, None]
        A = A_re + 1j * A_im
        Bc = B_re + 1j * B_im
        Cc = C_re + 1j * C_im
        logdA = dt * A
        dB = dt * Bc
        l = (lambda x, dt: x.to(dt))(torch.arange(L), A_re.dtype)
        P = torch.exp(logdA[:, :, None] * l[None, None, :])
        K = torch.einsum("dn,dnl,dn->dl", Cc, P, dB).real
        L2 = 2 * L
        Kp = _pad(K, ((0, 0), (0, L)))
        up = (lambda x, *d: x.permute(*d))(u, 0, 2, 1)
        up = _pad(up, ((0, 0), (0, 0), (0, L)))
        Kf = (lambda x, axes=(-2,-1): torch.fft.rfft2(x.float(), dim=axes))(Kp[:, None, :], axes=(-2, -1))
        Uf = (lambda x, axes=(-2,-1): torch.fft.rfft2(x.float(), dim=axes))(up[:, :, None, :], axes=(-2, -1))
        Yf = Uf * Kf[None, :, :, :]
        y = (lambda x, s, axes=(-2,-1): torch.fft.irfft2(x, s=s, dim=axes).to(torch.bfloat16))(Yf, (1, L2), axes=(-2, -1))[:, :, 0, :L]
        y = (lambda x, *d: x.permute(*d))(y, 0, 2, 1) + u * Dskip[None, None, :]
        return y

    def _B_ref(x, w1, w2, w3, w4):
        B, S, D = x.shape
        h = _gelu(_layernorm(x, axis=-1) @ w1)
        c = D // 4
        g0 = _pad(h[:, :, 0*c:1*c], ((0, 0), (1, 0), (0, 0)))[:, :S, :]
        g1 = _pad(h[:, :, 1*c:2*c], ((0, 0), (0, 1), (0, 0)))[:, 1:, :]
        g2 = _pad(h[:, :, 2*c:3*c], ((0, 0), (2, 0), (0, 0)))[:, :S, :]
        g3 = _pad(h[:, :, 3*c:   ], ((0, 0), (0, 2), (0, 0)))[:, 2:, :]
        hs = torch.concatenate([g0, g1, g2, g3], axis=-1) @ w2
        x1 = x + hs
        h2 = _gelu(_layernorm(x1, axis=-1) @ w3) @ w4
        return x1 + h2

    x = A_u
    xn = _layernorm(x, axis=-1)
    s = _A_ref(xn, A_A_re, A_A_im, A_B_re, A_B_im, A_C_re, A_C_im, A_log_dt, A_Dskip)
    g = _silu(_B_ref(xn, B_w1, B_w2, B_w3, B_w4))
    return x + s * g
```

```asm
; @launch grid=(256,1,1) block=(768,1,1) lds=163840
.amdgcn_target "amdgcn-amd-amdhsa--gfx950"
.text
.globl recurrent_scan__ssm_conv_s4__mixer_s_mlp__prompt_kernel
.p2align 8
.type recurrent_scan__ssm_conv_s4__mixer_s_mlp__prompt_kernel,@function
recurrent_scan__ssm_conv_s4__mixer_s_mlp__prompt_kernel:
K_start:
  s_cmp_ge_u32 s2, 256
  s_cbranch_scc1 L_exit
  s_load_dwordx16 s[16:31], s[0:1], 0
  s_load_dwordx16 s[32:47], s[0:1], 64
  s_load_dwordx2 s[48:49], s[0:1], 128
  s_getpc_b64 s[64:65]
K_pc:
  v_lshrrev_b32 v2, 6, v0
  v_and_b32 v0, 63, v0
  v_readfirstlane_b32 s3, v2
  s_and_b32 s10, s2, 7
  s_lshr_b32 s11, s2, 3
  s_and_b32 s12, s11, 3
  s_lshl2_add_u32 s4, s10, s12
  s_lshr_b32 s5, s2, 5
  s_lshl_b32 s6, s10, 5
  s_add_u32 s6, s6, s11
  s_lshr_b32 s8, s5, 2
  s_add_u32 s8, s8, 1
  s_sub_u32 s10, 0, s8
  s_bitcmp1_b32 s5, 1
  s_cselect_b32 s8, s8, s10
  s_cselect_b32 s9, 0, 2
  v_lshlrev_b32 v1, 2, v0
  v_add_u32 v1, 157184, v1
  v_mov_b32 v2, 0
  ds_write_b32 v1, v2
  s_mov_b32 s59, 0x20000
  s_and_b32 s15, s3, 3
  s_cmp_ge_u32 s3, 8
  s_cbranch_scc1 E_L
  s_cmp_ge_u32 s3, 4
  s_cbranch_scc1 E_B
  s_lshl4_add_u32 s11, s15, 2
  s_cmp_eq_u32 s15, 0
  s_cselect_b32 s11, 0, s11
  s_lshl_b32 s10, s4, 6
  s_add_u32 s10, s10, s11
  s_sub_u32 s10, s10, s9
  s_lshl_b32 s10, s10, 10
  v_lshlrev_b32 v1, 4, v0
  v_add_u32 v2, s10, v1
  s_mul_i32 s11, s11, 1040
  s_add_u32 s11, s11, 65536
  s_mov_b32 m0, s11
  s_cmp_eq_u32 s15, 0
  s_cselect_b32 s14, 8, 7
  s_mov_b32 s58, 0x200000
  s_lshl3_add_u32 s10, s4, s5
  s_lshl2_add_u32 s10, s10, s15
  s_lshl_b32 s10, s10, 11
  v_lshl_add_u32 v3, v0, 5, s10
  s_waitcnt lgkmcnt(0)
  s_mov_b64 s[56:57], s[16:17]
  s_branch E_go
E_B:
  s_and_b32 s10, s11, 7
  s_lshl2_add_u32 s10, s10, s15
  s_mul_i32 s10, s10, 1536
  v_min_u32 v1, 11, v0
  v_lshl_add_u32 v1, v1, 7, s10
  v_min_u32 v1, K_end-K_pc-4, v1
  global_load_dword v67, v1, s[64:65]
  s_lshl2_add_u32 s10, s6, s15
  s_lshl_b32 s10, s10, 7
  v_lshl_add_u32 v1, v0, 1, s10
  s_waitcnt lgkmcnt(0)
  s_nop 0
  global_load_ushort v36, v1, s[18:19]
  global_load_ushort v37, v1, s[20:21]
  global_load_ushort v38, v1, s[22:23]
  global_load_ushort v39, v1, s[24:25]
  global_load_ushort v40, v1, s[26:27]
  global_load_ushort v41, v1, s[28:29]
  s_barrier
  s_branch L_roleB
E_L:
  s_lshl_b32 s10, s5, 7
  s_lshl2_add_u32 s12, s2, s15
  s_lshl_b32 s12, s12, 9
  v_and_b32 v3, 3, v0
  v_lshl_add_u32 v3, v3, 7, s12
  s_mov_b32 s58, 0x80000
  s_waitcnt lgkmcnt(0)
  s_mov_b64 s[56:57], s[36:37]
E_go:
  buffer_load_dword v166, v3, s[56:59], 0 offen
E_go2:
  s_barrier
  v_mov_b32 v4, 157184
  s_cmp_ge_u32 s3, 8
  s_cbranch_scc1 L_roleL
E_loop:
  s_nop 0
  buffer_load_dwordx4 v2, s[56:59], 0 offen lds
  s_add_u32 m0, m0, 1040
  v_add_u32 v2, 0x400, v2
  buffer_load_dwordx4 v2, s[56:59], 0 offen lds
  s_add_u32 m0, m0, 1040
  v_add_u32 v2, 0x400, v2
  s_sub_u32 s14, s14, 1
  s_cbranch_scc0 E_loop
  s_mov_b32 s60, s36
  s_mov_b32 s61, s37
  s_mov_b32 s62, 0x00080000
  s_mov_b32 s63, 0x20000
  v_lshrrev_b32 v6, 3, v0
  v_and_b32 v7, 7, v0
  v_lshrrev_b32 v10, 2, v0
  v_and_b32 v10, 4, v10
  v_xor_b32 v7, v7, v10
  v_lshlrev_b32 v7, 4, v7
  v_lshl_add_u32 v5, v6, 10, v7
  s_lshl_b32 s12, s3, 15
  s_lshl_b32 s13, s5, 7
  s_add_u32 s64, s12, s13
  s_lshl_b32 m0, s3, 12
  s_nop 0
  s_nop 0
  buffer_load_dwordx4 v5, s[60:63], s64 offen lds
  s_add_u32 m0, m0, 1024
  s_add_u32 s64, s64, 8192
  buffer_load_dwordx4 v5, s[60:63], s64 offen lds
  s_add_u32 m0, m0, 1024
  s_add_u32 s64, s64, 8192
  buffer_load_dwordx4 v5, s[60:63], s64 offen lds
  s_add_u32 m0, m0, 1024
  s_add_u32 s64, s64, 8192
  buffer_load_dwordx4 v5, s[60:63], s64 offen lds
  s_add_u32 m0, m0, 13312
  s_add_u32 s64, s64, 106496
  buffer_load_dwordx4 v5, s[60:63], s64 offen lds
  s_add_u32 m0, m0, 1024
  s_add_u32 s64, s64, 8192
  buffer_load_dwordx4 v5, s[60:63], s64 offen lds
  s_add_u32 m0, m0, 1024
  s_add_u32 s64, s64, 8192
  buffer_load_dwordx4 v5, s[60:63], s64 offen lds
  s_add_u32 m0, m0, 1024
  s_add_u32 s64, s64, 8192
  buffer_load_dwordx4 v5, s[60:63], s64 offen lds
  s_add_u32 m0, m0, 13312
  s_add_u32 s64, s64, 106496
  v_mov_b32 v2, v4
  v_mov_b32 v4, 1
  s_setprio 2
  s_and_b32 s67, s4, 1
  s_lshl3_add_u32 s67, s67, s5
  s_mul_i32 s69, s4, 324608
  s_mov_b32 s68, 2097152
  s_mov_b32 s52, s48
  s_mov_b32 s53, s49
  s_mov_b32 s54, 0x01a00000
  s_mov_b32 s55, 0x20000
  s_lshr_b32 s10, s3, 1
  s_and_b32 s12, s3, 1
  v_and_b32 v64, 31, v0
  v_lshrrev_b32 v65, 5, v0
  v_mul_u32_u24 v66, 1040, v64
  v_lshl_add_u32 v66, v65, 3, v66
  s_lshl_b32 s72, s10, 5
  s_add_u32 s72, s72, s9
  s_add_u32 s73, s72, s8
  s_mul_i32 s73, s73, 1040
  s_add_u32 s73, s73, 65536
  v_add_u32 v67, s73, v66
  v_lshl_add_u32 v67, v65, 3, v67
  s_mul_i32 s72, s72, 1040
  s_lshl_b32 s73, s5, 7
  s_add_u32 s72, s72, s73
  s_lshl_b32 s73, s12, 6
  s_add_u32 s72, s72, s73
  s_add_u32 s72, s72, 65536
  v_add_u32 v68, s72, v66
  v_lshrrev_b32 v22, 5, v0
  v_bfe_u32 v23, v0, 2, 2
  v_lshl_add_u32 v6, v22, 2, v23
  v_lshlrev_b32 v6, 7, v6
  v_and_b32 v22, 2, v23
  v_bfe_u32 v23, v0, 4, 1
  v_xor_b32 v22, v22, v23
  v_lshl_add_u32 v6, v22, 5, v6
  v_and_b32 v22, 3, v0
  v_lshl_add_u32 v6, v22, 3, v6
  s_mul_i32 s72, s12, 8256
  v_xor_b32 v6, s72, v6
  v_xor_b32 v8, 64, v6
  v_and_b32 v72, 0x1fff, v6
  v_lshl_add_u32 v72, v65, 9, v72
  s_lshl_b32 s73, s10, 14
  v_add_u32 v72, s73, v72
  v_xor_b32 v73, 0x4000, v72
  s_lshl_b32 s73, s10, 8
  v_add_u32 v74, s73, v67
  s_xor_b32 s73, s73, 0x100
  v_add_u32 v75, s73, v67
  v_and_b32 v22, 15, v0
  v_bfe_u32 v23, v0, 4, 1
  v_cmp_eq_u32 vcc, v22, v23
  v_mov_b32 v22, 0x3f803f80
  s_nop 0
  v_cndmask_b32 v76, 0, v22, vcc
  v_cndmask_b32 v77, 0, v22, vcc
  v_cndmask_b32 v78, 0, v22, vcc
  v_cndmask_b32 v79, 0, v22, vcc
  v_add_u32 v7, 0x10000, v6
  v_add_u32 v9, 0x10000, v8
  s_lshl_b32 s72, s3, 2
  v_add_u32 v3, s72, v2
  v_and_b32 v22, 3, v0
  v_lshlrev_b32 v17, 4, v22
  v_and_b32 v22, 4, v0
  v_add_u32 v17, v17, v22
  s_lshl_b32 s72, s12, 3
  v_add_u32 v17, s72, v17
  s_lshl_b32 s72, s3, 12
  v_add_u32 v19, s72, v1
  s_mov_b32 s70, 0xbdd2d3e8
  v_mov_b32 v18, 0xc0135761
  s_mul_i32 s11, s10, 153600
  s_add_u32 s11, s11, s69
  s_add_u32 s50, s11, 0
  s_lshl1_add_u32 s72, s5, s12
  s_lshl_b32 s14, s72, 11
  s_add_u32 s14, s14, s50
  s_lshl_b32 s15, s10, 7
  s_add_u32 s15, s15, s69
  s_add_u32 s15, s15, 315392
  s_lshl2_add_u32 s51, s72, s15
  s_lshl_b32 s72, s10, 7
  s_add_u32 s72, s72, 160512
  v_and_b32 v69, 31, v0
  v_lshl_add_u32 v69, v69, 2, s72
  s_lshl_b32 s72, s12, 7
  s_add_u32 s72, s72, 158464
  v_lshrrev_b32 v70, 5, v0
  v_lshl_add_u32 v70, v70, 4, s72
  s_lshl_b32 s72, s8, 2
  v_add_u32 v71, s72, v69
  s_waitcnt vmcnt(8)
  s_barrier
  s_nop 0
  buffer_load_dwordx4 v5, s[60:63], s64 offen lds
  s_add_u32 m0, m0, 1024
  s_add_u32 s64, s64, 8192
  buffer_load_dwordx4 v5, s[60:63], s64 offen lds
  s_add_u32 m0, m0, 1024
  s_add_u32 s64, s64, 8192
  buffer_load_dwordx4 v5, s[60:63], s64 offen lds
  s_add_u32 m0, m0, 1024
  s_add_u32 s64, s64, 8192
  buffer_load_dwordx4 v5, s[60:63], s64 offen lds
  s_add_u32 m0, m0, 13312
  s_add_u32 s64, s64, 106496
  buffer_load_dwordx4 v5, s[60:63], s64 offen lds
  s_add_u32 m0, m0, 1024
  s_add_u32 s64, s64, 8192
  buffer_load_dwordx4 v5, s[60:63], s64 offen lds
  s_add_u32 m0, m0, 1024
  s_add_u32 s64, s64, 8192
  buffer_load_dwordx4 v5, s[60:63], s64 offen lds
  s_add_u32 m0, m0, 1024
  s_add_u32 s64, s64, 8192
  buffer_load_dwordx4 v5, s[60:63], s64 offen lds
  ds_read_b128 v[104:107], v74 offset:0
  ds_read_b128 v[108:111], v74 offset:32
  ds_read_b128 v[112:115], v74 offset:64
  ds_read_b128 v[116:119], v74 offset:96
  ds_read_b128 v[120:123], v74 offset:128
  ds_read_b128 v[124:127], v74 offset:160
  ds_read_b128 v[128:131], v74 offset:192
  ds_read_b128 v[132:135], v74 offset:224
  ds_read_b128 v[136:139], v75 offset:0
  ds_read_b128 v[140:143], v75 offset:32
  ds_read_b128 v[144:147], v75 offset:64
  ds_read_b128 v[148:151], v75 offset:96
  ds_read_b128 v[152:155], v75 offset:128
  ds_read_b128 v[156:159], v75 offset:160
  ds_read_b128 v[160:163], v75 offset:192
  ds_read_b128 v[164:167], v75 offset:224
  ds_read_b128 v[48:51], v74 offset:512
  ds_read_b128 v[52:55], v74 offset:544
  ds_read_b128 v[56:59], v74 offset:576
  ds_read_b128 v[60:63], v74 offset:608
  ds_read_b64 v[24:25], v68 offset:0
  ds_read_b64 v[26:27], v68 offset:16
  ds_read_b64 v[28:29], v68 offset:32
  ds_read_b64 v[30:31], v68 offset:48
  s_waitcnt vmcnt(8) lgkmcnt(0)
  s_barrier
  ds_read_b64_tr_b16 v[80:81], v72 offset:0
  ds_read_b64_tr_b16 v[82:83], v72 offset:512
  ds_read_b64_tr_b16 v[84:85], v72 offset:2048
  ds_read_b64_tr_b16 v[86:87], v72 offset:2560
  ds_read_b64_tr_b16 v[88:89], v72 offset:4096
  ds_read_b64_tr_b16 v[90:91], v72 offset:4608
  ds_read_b64_tr_b16 v[92:93], v72 offset:6144
  ds_read_b64_tr_b16 v[94:95], v72 offset:6656
  ds_read_b64_tr_b16 v[96:97], v72 offset:8192
  ds_read_b64_tr_b16 v[98:99], v72 offset:8704
  s_waitcnt lgkmcnt(6)
  v_mfma_f32_32x32x16_bf16 v[32:47], v[80:83], v[104:107], 0
  ds_read_b64_tr_b16 v[100:101], v72 offset:10240
  ds_read_b64_tr_b16 v[102:103], v72 offset:10752
  v_mfma_f32_16x16x32_bf16 v[10:13], v[76:79], v[80:83], 0
  v_mfma_f32_32x32x16_bf16 v[32:47], v[84:87], v[108:111], v[32:47]
  ds_read_b64_tr_b16 v[80:81], v72 offset:12288
  ds_read_b64_tr_b16 v[82:83], v72 offset:12800
  v_mfma_f32_16x16x32_bf16 v[10:13], v[76:79], v[84:87], v[10:13]
  ds_read_b128 v[104:107], v74 offset:640
  s_waitcnt lgkmcnt(7)
  v_mfma_f32_32x32x16_bf16 v[32:47], v[88:91], v[112:115], v[32:47]
  ds_read_b64_tr_b16 v[84:85], v72 offset:14336
  ds_read_b64_tr_b16 v[86:87], v72 offset:14848
  v_mfma_f32_16x16x32_bf16 v[10:13], v[76:79], v[88:91], v[10:13]
  ds_read_b128 v[108:111], v74 offset:672
  v_mfma_f32_32x32x16_bf16 v[32:47], v[92:95], v[116:119], v[32:47]
  ds_read_b64_tr_b16 v[88:89], v73 offset:0
  ds_read_b64_tr_b16 v[90:91], v73 offset:512
  v_mfma_f32_16x16x32_bf16 v[10:13], v[76:79], v[92:95], v[10:13]
  ds_read_b128 v[112:115], v74 offset:704
  s_waitcnt lgkmcnt(9)
  v_mfma_f32_32x32x16_bf16 v[32:47], v[96:99], v[120:123], v[32:47]
  ds_read_b64_tr_b16 v[92:93], v73 offset:2048
  ds_read_b64_tr_b16 v[94:95], v73 offset:2560
  v_mfma_f32_16x16x32_bf16 v[10:13], v[76:79], v[96:99], v[10:13]
  ds_read_b128 v[116:119], v74 offset:736
  v_mfma_f32_32x32x16_bf16 v[32:47], v[100:103], v[124:127], v[32:47]
  ds_read_b64_tr_b16 v[96:97], v73 offset:4096
  ds_read_b64_tr_b16 v[98:99], v73 offset:4608
  v_mfma_f32_16x16x32_bf16 v[10:13], v[76:79], v[100:103], v[10:13]
  ds_read_b128 v[120:123], v75 offset:512
  s_waitcnt lgkmcnt(10)
  v_mfma_f32_32x32x16_bf16 v[32:47], v[80:83], v[128:131], v[32:47]
  ds_read_b64_tr_b16 v[100:101], v73 offset:6144
  ds_read_b64_tr_b16 v[102:103], v73 offset:6656
  v_mfma_f32_16x16x32_bf16 v[10:13], v[76:79], v[80:83], v[10:13]
  ds_read_b128 v[124:127], v75 offset:544
  v_mfma_f32_32x32x16_bf16 v[32:47], v[84:87], v[132:135], v[32:47]
  ds_read_b64_tr_b16 v[80:81], v73 offset:8192
  ds_read_b64_tr_b16 v[82:83], v73 offset:8704
  v_mfma_f32_16x16x32_bf16 v[10:13], v[76:79], v[84:87], v[10:13]
  ds_read_b128 v[128:131], v75 offset:576
  s_waitcnt lgkmcnt(10)
  v_mfma_f32_32x32x16_bf16 v[32:47], v[88:91], v[136:139], v[32:47]
  ds_read_b64_tr_b16 v[84:85], v73 offset:10240
  ds_read_b64_tr_b16 v[86:87], v73 offset:10752
  ds_read_b128 v[132:135], v75 offset:608
  s_waitcnt vmcnt(0)
  s_mov_b64 exec, 1
  ds_add_u32 v2, v4 offset:116
  s_mov_b64 exec, -1
  v_mfma_f32_32x32x16_bf16 v[32:47], v[92:95], v[140:143], v[32:47]
  ds_read_b64_tr_b16 v[88:89], v73 offset:12288
  ds_read_b64_tr_b16 v[90:91], v73 offset:12800
  ds_read_b128 v[136:139], v75 offset:640
  s_waitcnt lgkmcnt(11)
  s_nop 0
  v_mfma_f32_32x32x16_bf16 v[32:47], v[96:99], v[144:147], v[32:47]
  ds_read_b64_tr_b16 v[92:93], v73 offset:14336
  ds_read_b64_tr_b16 v[94:95], v73 offset:14848
  ds_read_b128 v[140:143], v75 offset:672
SL_1:
  ds_read_b32 v22, v2 offset:116
  s_waitcnt lgkmcnt(0)
  v_cmp_gt_u32 vcc, 4, v22
  s_cbranch_vccz SD_2
  s_sub_u32 s68, s68, 1
  s_cbranch_scc0 SL_1
  s_mov_b32 s68, 0
SD_2:
  v_mfma_f32_32x32x16_bf16 v[32:47], v[100:103], v[148:151], v[32:47]
  ds_read_b64_tr_b16 v[96:97], v72 offset:32768
  ds_read_b64_tr_b16 v[98:99], v72 offset:33280
  ds_read_b128 v[144:147], v75 offset:704
  v_mfma_f32_32x32x16_bf16 v[32:47], v[80:83], v[152:155], v[32:47]
  ds_read_b64_tr_b16 v[100:101], v72 offset:34816
  ds_read_b64_tr_b16 v[102:103], v72 offset:35328
  ds_read_b128 v[148:151], v75 offset:736
  v_mfma_f32_32x32x16_bf16 v[32:47], v[84:87], v[156:159], v[32:47]
  ds_read_b64_tr_b16 v[80:81], v72 offset:36864
  ds_read_b64_tr_b16 v[82:83], v72 offset:37376
  s_mov_b64 exec, 1
  ds_add_u32 v2, v4 offset:88
  s_mov_b64 exec, -1
  v_mfma_f32_32x32x16_bf16 v[32:47], v[88:91], v[160:163], v[32:47]
  ds_read_b64_tr_b16 v[84:85], v72 offset:38912
  ds_read_b64_tr_b16 v[86:87], v72 offset:39424
  ds_write_b32 v3, v4 offset:144
  v_mfma_f32_32x32x16_bf16 v[32:47], v[92:95], v[164:167], v[32:47]
  ds_read_b64_tr_b16 v[88:89], v72 offset:40960
  ds_read_b64_tr_b16 v[90:91], v72 offset:41472
  s_waitcnt lgkmcnt(9)
  v_mfma_f32_32x32x16_bf16 v[32:47], v[96:99], v[48:51], v[32:47]
  ds_read_b64_tr_b16 v[92:93], v72 offset:43008
  ds_read_b64_tr_b16 v[94:95], v72 offset:43520
  v_mfma_f32_16x16x32_bf16 v[10:13], v[76:79], v[96:99], v[10:13]
  v_mfma_f32_32x32x16_bf16 v[32:47], v[100:103], v[52:55], v[32:47]
  ds_read_b64_tr_b16 v[96:97], v72 offset:45056
  ds_read_b64_tr_b16 v[98:99], v72 offset:45568
  v_mfma_f32_16x16x32_bf16 v[10:13], v[76:79], v[100:103], v[10:13]
  s_waitcnt lgkmcnt(7)
  v_mfma_f32_32x32x16_bf16 v[32:47], v[80:83], v[56:59], v[32:47]
  ds_read_b64_tr_b16 v[100:101], v72 offset:47104
  ds_read_b64_tr_b16 v[102:103], v72 offset:47616
  v_mfma_f32_16x16x32_bf16 v[10:13], v[76:79], v[80:83], v[10:13]
  v_mfma_f32_32x32x16_bf16 v[32:47], v[84:87], v[60:63], v[32:47]
  ds_read_b64_tr_b16 v[80:81], v73 offset:32768
  ds_read_b64_tr_b16 v[82:83], v73 offset:33280
  v_mfma_f32_16x16x32_bf16 v[10:13], v[76:79], v[84:87], v[10:13]
  s_waitcnt lgkmcnt(6)
  v_mfma_f32_32x32x16_bf16 v[32:47], v[88:91], v[104:107], v[32:47]
  ds_read_b64_tr_b16 v[84:85], v73 offset:34816
  ds_read_b64_tr_b16 v[86:87], v73 offset:35328
  v_mfma_f32_16x16x32_bf16 v[10:13], v[76:79], v[88:91], v[10:13]
  v_mfma_f32_32x32x16_bf16 v[32:47], v[92:95], v[108:111], v[32:47]
  ds_read_b64_tr_b16 v[88:89], v73 offset:36864
  ds_read_b64_tr_b16 v[90:91], v73 offset:37376
  v_mfma_f32_16x16x32_bf16 v[10:13], v[76:79], v[92:95], v[10:13]
  s_waitcnt lgkmcnt(6)
  v_mfma_f32_32x32x16_bf16 v[32:47], v[96:99], v[112:115], v[32:47]
  ds_read_b64_tr_b16 v[92:93], v73 offset:38912
  ds_read_b64_tr_b16 v[94:95], v73 offset:39424
  v_mfma_f32_16x16x32_bf16 v[10:13], v[76:79], v[96:99], v[10:13]
  s_lshl_b32 s72, s3, 7
  s_add_u32 s72, s72, 158464
  v_lshl_add_u32 v23, v0, 2, s72
  v_xor_b32 v68, 8, v3
  v_mfma_f32_32x32x16_bf16 v[32:47], v[100:103], v[116:119], v[32:47]
  ds_read_b64_tr_b16 v[96:97], v73 offset:40960
  ds_read_b64_tr_b16 v[98:99], v73 offset:41472
  v_mfma_f32_16x16x32_bf16 v[10:13], v[76:79], v[100:103], v[10:13]
  s_waitcnt lgkmcnt(6)
  v_mfma_f32_32x32x16_bf16 v[32:47], v[80:83], v[120:123], v[32:47]
  ds_read_b64_tr_b16 v[100:101], v73 offset:43008
  ds_read_b64_tr_b16 v[102:103], v73 offset:43520
  v_mfma_f32_32x32x16_bf16 v[32:47], v[84:87], v[124:127], v[32:47]
  ds_read_b64_tr_b16 v[80:81], v73 offset:45056
  ds_read_b64_tr_b16 v[82:83], v73 offset:45568
  s_waitcnt lgkmcnt(6)
  v_mfma_f32_32x32x16_bf16 v[32:47], v[88:91], v[128:131], v[32:47]
  ds_read_b64_tr_b16 v[84:85], v73 offset:47104
  ds_read_b64_tr_b16 v[86:87], v73 offset:47616
  s_mov_b64 exec, 0xffff
  ds_write2_b32 v23, v10, v11 offset0:0 offset1:16
  ds_write_b32 v3, v4 offset:64
  s_mov_b64 exec, -1
  v_mfma_f32_32x32x16_bf16 v[32:47], v[92:95], v[132:135], v[32:47]
  v_mov_b32 v22, 5
  ds_write_b32 v3, v22 offset:16
  s_waitcnt lgkmcnt(7)
  v_mfma_f32_32x32x16_bf16 v[32:47], v[96:99], v[136:139], v[32:47]
  v_mfma_f32_32x32x16_bf16 v[32:47], v[100:103], v[140:143], v[32:47]
  s_waitcnt lgkmcnt(3)
  v_mfma_f32_32x32x16_bf16 v[32:47], v[80:83], v[144:147], v[32:47]
  ds_read_b32 v64, v68 offset:64
  ds_read_b32 v65, v2 offset:84
  ds_read_b64 v[66:67], v2 offset:96
  ds_read_b128 v[152:155], v70 offset:0
  ds_read_b128 v[48:51], v70 offset:256
  ds_read_b128 v[156:159], v70 offset:32
  ds_read_b128 v[52:55], v70 offset:288
  ds_read_b128 v[160:163], v70 offset:64
  ds_read_b128 v[56:59], v70 offset:320
  ds_read_b128 v[164:167], v70 offset:96
  ds_read_b128 v[60:63], v70 offset:352
  ds_read_b32 v14, v71 offset:592
  ds_read_b32 v16, v71 offset:880
  ds_read_b32 v20, v69 offset:16
  ds_read_b32 v21, v69 offset:304
  v_mfma_f32_32x32x16_bf16 v[32:47], v[84:87], v[148:151], v[32:47]
  s_waitcnt lgkmcnt(0)
  v_lshrrev_b32 v65, 2, v65
  v_min3_u32 v64, v64, v65, v66
  v_cmp_eq_u32 vcc, 0, v64
  s_cbranch_vccz SD_5
SL_4:
  s_sub_u32 s68, s68, 1
  s_cbranch_scc1 ST_6
  ds_read_b32 v64, v68 offset:64
  ds_read_b32 v65, v2 offset:84
  ds_read_b64 v[66:67], v2 offset:96
  ds_read_b128 v[152:155], v70 offset:0
  ds_read_b128 v[48:51], v70 offset:256
  ds_read_b128 v[156:159], v70 offset:32
  ds_read_b128 v[52:55], v70 offset:288
  ds_read_b128 v[160:163], v70 offset:64
  ds_read_b128 v[56:59], v70 offset:320
  ds_read_b128 v[164:167], v70 offset:96
  ds_read_b128 v[60:63], v70 offset:352
  ds_read_b32 v14, v71 offset:592
  ds_read_b32 v16, v71 offset:880
  ds_read_b32 v20, v69 offset:16
  ds_read_b32 v21, v69 offset:304
  s_waitcnt lgkmcnt(0)
  v_lshrrev_b32 v65, 2, v65
  v_min3_u32 v64, v64, v65, v66
  v_cmp_eq_u32 vcc, 0, v64
  s_cbranch_vccnz SL_4
SD_5:
  v_pk_add_f32 v[152:153], v[152:153], v[48:49]
  v_pk_add_f32 v[154:155], v[154:155], v[50:51]
  v_pk_add_f32 v[156:157], v[156:157], v[52:53]
  v_pk_add_f32 v[158:159], v[158:159], v[54:55]
  v_pk_add_f32 v[160:161], v[160:161], v[56:57]
  v_pk_add_f32 v[162:163], v[162:163], v[58:59]
  v_pk_add_f32 v[164:165], v[164:165], v[60:61]
  v_pk_add_f32 v[166:167], v[166:167], v[62:63]
  v_readfirstlane_b32 s13, v66
  v_mov_b32 v15, v67
  v_pk_fma_f32 v[32:33], v[152:153], v[14:15], v[32:33] op_sel_hi:[1,0,1]
  v_pk_fma_f32 v[34:35], v[154:155], v[14:15], v[34:35] op_sel_hi:[1,0,1]
  v_pk_fma_f32 v[36:37], v[156:157], v[14:15], v[36:37] op_sel_hi:[1,0,1]
  v_pk_fma_f32 v[38:39], v[158:159], v[14:15], v[38:39] op_sel_hi:[1,0,1]
  v_pk_fma_f32 v[40:41], v[160:161], v[14:15], v[40:41] op_sel_hi:[1,0,1]
  v_pk_fma_f32 v[42:43], v[162:163], v[14:15], v[42:43] op_sel_hi:[1,0,1]
  v_pk_fma_f32 v[44:45], v[164:165], v[14:15], v[44:45] op_sel_hi:[1,0,1]
  v_pk_fma_f32 v[46:47], v[166:167], v[14:15], v[46:47] op_sel_hi:[1,0,1]
  v_pk_mul_f32 v[32:33], v[32:33], v[16:17] op_sel_hi:[1,0]
  v_pk_mul_f32 v[34:35], v[34:35], v[16:17] op_sel_hi:[1,0]
  v_pk_mul_f32 v[36:37], v[36:37], v[16:17] op_sel_hi:[1,0]
  v_pk_mul_f32 v[38:39], v[38:39], v[16:17] op_sel_hi:[1,0]
  v_pk_mul_f32 v[40:41], v[40:41], v[16:17] op_sel_hi:[1,0]
  v_pk_mul_f32 v[42:43], v[42:43], v[16:17] op_sel_hi:[1,0]
  v_pk_mul_f32 v[44:45], v[44:45], v[16:17] op_sel_hi:[1,0]
  v_pk_mul_f32 v[46:47], v[46:47], v[16:17] op_sel_hi:[1,0]
  v_pk_mul_f32 v[152:153], v[32:33], v[32:33]
  v_pk_mul_f32 v[154:155], v[34:35], v[34:35]
  v_pk_mul_f32 v[156:157], v[36:37], v[36:37]
  v_pk_mul_f32 v[158:159], v[38:39], v[38:39]
  v_pk_mul_f32 v[160:161], v[40:41], v[40:41]
  v_pk_mul_f32 v[162:163], v[42:43], v[42:43]
  v_pk_mul_f32 v[164:165], v[44:45], v[44:45]
  v_pk_mul_f32 v[166:167], v[46:47], v[46:47]
  v_pk_fma_f32 v[152:153], v[152:153], s[70:71], v[18:19] op_sel_hi:[1,0,0]
  v_pk_fma_f32 v[154:155], v[154:155], s[70:71], v[18:19] op_sel_hi:[1,0,0]
  v_pk_fma_f32 v[156:157], v[156:157], s[70:71], v[18:19] op_sel_hi:[1,0,0]
  v_pk_fma_f32 v[158:159], v[158:159], s[70:71], v[18:19] op_sel_hi:[1,0,0]
  v_pk_fma_f32 v[160:161], v[160:161], s[70:71], v[18:19] op_sel_hi:[1,0,0]
  v_pk_fma_f32 v[162:163], v[162:163], s[70:71], v[18:19] op_sel_hi:[1,0,0]
  v_pk_fma_f32 v[164:165], v[164:165], s[70:71], v[18:19] op_sel_hi:[1,0,0]
  v_pk_fma_f32 v[166:167], v[166:167], s[70:71], v[18:19] op_sel_hi:[1,0,0]
  v_pk_mul_f32 v[152:153], v[152:153], v[32:33]
  v_pk_mul_f32 v[154:155], v[154:155], v[34:35]
  v_pk_mul_f32 v[156:157], v[156:157], v[36:37]
  v_pk_mul_f32 v[158:159], v[158:159], v[38:39]
  v_pk_mul_f32 v[160:161], v[160:161], v[40:41]
  v_pk_mul_f32 v[162:163], v[162:163], v[42:43]
  v_pk_mul_f32 v[164:165], v[164:165], v[44:45]
  v_pk_mul_f32 v[166:167], v[166:167], v[46:47]
  v_exp_f32 v152, v152
  v_exp_f32 v153, v153
  v_exp_f32 v154, v154
  v_exp_f32 v155, v155
  v_exp_f32 v156, v156
  v_exp_f32 v157, v157
  v_exp_f32 v158, v158
  v_exp_f32 v159, v159
  v_exp_f32 v160, v160
  v_exp_f32 v161, v161
  v_exp_f32 v162, v162
  v_exp_f32 v163, v163
  v_exp_f32 v164, v164
  v_exp_f32 v165, v165
  v_exp_f32 v166, v166
  v_exp_f32 v167, v167
  v_pk_add_f32 v[152:153], v[152:153], 1.0 op_sel_hi:[1,0]
  v_pk_add_f32 v[154:155], v[154:155], 1.0 op_sel_hi:[1,0]
  v_pk_add_f32 v[156:157], v[156:157], 1.0 op_sel_hi:[1,0]
  v_pk_add_f32 v[158:159], v[158:159], 1.0 op_sel_hi:[1,0]
  v_pk_add_f32 v[160:161], v[160:161], 1.0 op_sel_hi:[1,0]
  v_pk_add_f32 v[162:163], v[162:163], 1.0 op_sel_hi:[1,0]
  v_pk_add_f32 v[164:165], v[164:165], 1.0 op_sel_hi:[1,0]
  v_pk_add_f32 v[166:167], v[166:167], 1.0 op_sel_hi:[1,0]
  v_rcp_f32 v152, v152
  v_rcp_f32 v153, v153
  v_rcp_f32 v154, v154
  v_rcp_f32 v155, v155
  v_rcp_f32 v156, v156
  v_rcp_f32 v157, v157
  v_rcp_f32 v158, v158
  v_rcp_f32 v159, v159
  v_rcp_f32 v160, v160
  v_rcp_f32 v161, v161
  v_rcp_f32 v162, v162
  v_rcp_f32 v163, v163
  v_rcp_f32 v164, v164
  v_rcp_f32 v165, v165
  v_rcp_f32 v166, v166
  v_rcp_f32 v167, v167
  v_pk_mul_f32 v[32:33], v[152:153], v[32:33]
  v_pk_mul_f32 v[34:35], v[154:155], v[34:35]
  v_pk_mul_f32 v[36:37], v[156:157], v[36:37]
  v_pk_mul_f32 v[38:39], v[158:159], v[38:39]
  v_pk_mul_f32 v[40:41], v[160:161], v[40:41]
  v_pk_mul_f32 v[42:43], v[162:163], v[42:43]
  v_pk_mul_f32 v[44:45], v[164:165], v[44:45]
  v_pk_mul_f32 v[46:47], v[166:167], v[46:47]
  v_cvt_pk_bf16_f32 v48, v32, v33
  v_cvt_pk_bf16_f32 v49, v34, v35
  v_cvt_pk_bf16_f32 v50, v36, v37
  v_cvt_pk_bf16_f32 v51, v38, v39
  v_cvt_pk_bf16_f32 v52, v40, v41
  v_cvt_pk_bf16_f32 v53, v42, v43
  v_cvt_pk_bf16_f32 v54, v44, v45
  v_cvt_pk_bf16_f32 v55, v46, v47
  buffer_store_dwordx4 v[48:51], v1, s[52:55], s14 offen offset:0 sc1
  buffer_store_dwordx4 v[52:55], v1, s[52:55], s14 offen offset:1024 sc1
  v_mov_b32 v22, 0
  ds_write_b32 v3, v22 offset:144
  v_mov_b64 v[160:161], v[24:25]
  v_mov_b64 v[162:163], v[26:27]
  v_mov_b64 v[164:165], v[28:29]
  v_mov_b64 v[166:167], v[30:31]
  v_lshlrev_b32 v32, 16, v24
  v_and_b32 v33, 0xffff0000, v24
  v_lshlrev_b32 v34, 16, v25
  v_and_b32 v35, 0xffff0000, v25
  v_lshlrev_b32 v36, 16, v26
  v_and_b32 v37, 0xffff0000, v26
  v_lshlrev_b32 v38, 16, v27
  v_and_b32 v39, 0xffff0000, v27
  v_lshlrev_b32 v40, 16, v28
  v_and_b32 v41, 0xffff0000, v28
  v_lshlrev_b32 v42, 16, v29
  v_and_b32 v43, 0xffff0000, v29
  v_lshlrev_b32 v44, 16, v30
  v_and_b32 v45, 0xffff0000, v30
  v_lshlrev_b32 v46, 16, v31
  v_and_b32 v47, 0xffff0000, v31
  v_sub_f32 v32, v32, v20
  v_sub_f32 v33, v33, v20
  v_sub_f32 v34, v34, v20
  v_sub_f32 v35, v35, v20
  v_sub_f32 v36, v36, v20
  v_sub_f32 v37, v37, v20
  v_sub_f32 v38, v38, v20
  v_sub_f32 v39, v39, v20
  v_sub_f32 v40, v40, v20
  v_sub_f32 v41, v41, v20
  v_sub_f32 v42, v42, v20
  v_sub_f32 v43, v43, v20
  v_sub_f32 v44, v44, v20
  v_sub_f32 v45, v45, v20
  v_sub_f32 v46, v46, v20
  v_sub_f32_e64 v47, v47, v20
  v_cvt_pk_bf16_f32 v24, v32, v33
  v_cvt_pk_bf16_f32 v25, v34, v35
  v_cvt_pk_bf16_f32 v26, v36, v37
  v_cvt_pk_bf16_f32 v27, v38, v39
  v_cvt_pk_bf16_f32 v28, v40, v41
  v_cvt_pk_bf16_f32 v29, v42, v43
  v_cvt_pk_bf16_f32 v30, v44, v45
  v_cvt_pk_bf16_f32 v31, v46, v47
  v_lshlrev_b32 v32, 16, v24
  v_and_b32 v33, 0xffff0000, v24
  v_lshlrev_b32 v34, 16, v25
  v_and_b32 v35, 0xffff0000, v25
  v_lshlrev_b32 v36, 16, v26
  v_and_b32 v37, 0xffff0000, v26
  v_lshlrev_b32 v38, 16, v27
  v_and_b32 v39, 0xffff0000, v27
  v_lshlrev_b32 v40, 16, v28
  v_and_b32 v41, 0xffff0000, v28
  v_lshlrev_b32 v42, 16, v29
  v_and_b32 v43, 0xffff0000, v29
  v_lshlrev_b32 v44, 16, v30
  v_and_b32 v45, 0xffff0000, v30
  v_lshlrev_b32 v46, 16, v31
  v_and_b32 v47, 0xffff0000, v31
  s_waitcnt vmcnt(0)
  s_cmp_eq_u32 s13, 1
  s_cbranch_scc0 PS_7
  buffer_store_dword v15, off, s[52:55], s51 offset:0
PB_8:
  v_mul_f32 v32, v32, v21
  v_mul_f32 v33, v33, v21
  v_mul_f32 v34, v34, v21
  v_mul_f32 v35, v35, v21
  v_mul_f32 v36, v36, v21
  v_mul_f32 v37, v37, v21
  v_mul_f32 v38, v38, v21
  v_mul_f32 v39, v39, v21
  v_mul_f32 v40, v40, v21
  v_mul_f32 v41, v41, v21
  v_mul_f32 v42, v42, v21
  v_mul_f32 v43, v43, v21
  v_mul_f32 v44, v44, v21
  v_mul_f32 v45, v45, v21
  v_mul_f32 v46, v46, v21
  v_mul_f32_e64 v47, v47, v21
  v_cvt_pk_bf16_f32 v24, v32, v33
  v_cvt_pk_bf16_f32 v25, v34, v35
  v_cvt_pk_bf16_f32 v26, v36, v37
  v_cvt_pk_bf16_f32 v27, v38, v39
  v_cvt_pk_bf16_f32 v28, v40, v41
  v_cvt_pk_bf16_f32 v29, v42, v43
  v_cvt_pk_bf16_f32 v30, v44, v45
  v_cvt_pk_bf16_f32 v31, v46, v47
  v_lshlrev_b32 v32, 16, v24
  v_and_b32 v33, 0xffff0000, v24
  v_lshlrev_b32 v34, 16, v25
  v_and_b32 v35, 0xffff0000, v25
  v_lshlrev_b32 v36, 16, v26
  v_and_b32 v37, 0xffff0000, v26
  v_lshlrev_b32 v38, 16, v27
  v_and_b32 v39, 0xffff0000, v27
  v_lshlrev_b32 v40, 16, v28
  v_and_b32 v41, 0xffff0000, v28
  v_lshlrev_b32 v42, 16, v29
  v_and_b32 v43, 0xffff0000, v29
  v_lshlrev_b32 v44, 16, v30
  v_and_b32 v45, 0xffff0000, v30
  v_lshlrev_b32 v46, 16, v31
  v_and_b32 v47, 0xffff0000, v31
  s_lshl_b32 s72, s12, 12
  s_add_u32 s50, s50, s72
  ds_read_b128 v[10:13], v2
  s_waitcnt lgkmcnt(0)
  v_min3_u32 v10, v10, v11, v12
  v_min_u32 v10, v10, v13
  s_nop 0
  v_readfirstlane_b32 s66, v10
  s_cmp_lt_u32 s66, 6
  s_cbranch_scc1 SL_9
SD_10:
  ds_read_b64_tr_b16 v[80:81], v9 offset:16384
  ds_read_b64_tr_b16 v[82:83], v9 offset:17408
  ds_read_b64_tr_b16 v[84:85], v7 offset:16384
  ds_read_b64_tr_b16 v[86:87], v7 offset:17408
  ds_read_b64_tr_b16 v[88:89], v9 offset:18432
  ds_read_b64_tr_b16 v[90:91], v9 offset:19456
  ds_read_b64_tr_b16 v[92:93], v7 offset:18432
  ds_read_b64_tr_b16 v[94:95], v7 offset:19456
  ds_read_b64_tr_b16 v[96:97], v9 offset:20480
  ds_read_b64_tr_b16 v[98:99], v9 offset:21504
  s_add_u32 s14, s14, 0x00008000
  v_and_b32 v64, 31, v0
  v_lshrrev_b32 v65, 5, v0
  v_lshlrev_b32 v66, 3, v64
  v_lshl_add_u32 v66, v65, 2, v66
  s_lshl1_add_u32 s75, s5, s12
  s_lshl1_add_u32 s75, s75, s10
  s_lshl_b32 s75, s75, 8
  s_add_u32 s75, s75, s69
  s_add_u32 s75, s75, 307200
  v_and_b32 v5, 15, v0
  v_lshlrev_b32 v5, 7, v5
  s_lshr_b32 s72, s5, 1
  s_lshl_b32 s72, s72, 13
  s_and_b32 s73, s5, 1
  s_lshl_b32 s73, s73, 11
  s_add_u32 s72, s72, s73
  s_add_u32 s72, s72, s50
SL_12:
  buffer_load_dword v23, v17, s[52:55], s15 offen offset:0 sc1
  s_waitcnt vmcnt(0)
  v_cmp_ne_u32 vcc, v15, v23
  s_cbranch_vccz SD_13
  s_sub_u32 s68, s68, 1
  s_cbranch_scc0 SL_12
  s_mov_b32 s68, 0
SD_13:
  s_nop 0
  buffer_load_dwordx4 v[104:107], v1, s[52:55], s50 offen offset:0 sc1
  buffer_load_dwordx4 v[108:111], v1, s[52:55], s50 offen offset:1024 sc1
  buffer_load_dwordx4 v[112:115], v1, s[52:55], s50 offen offset:2048 sc1
  buffer_load_dwordx4 v[116:119], v1, s[52:55], s50 offen offset:3072 sc1
  s_add_u32 s50, s50, 8192
  buffer_load_dwordx4 v[120:123], v1, s[52:55], s50 offen offset:0 sc1
  buffer_load_dwordx4 v[124:127], v1, s[52:55], s50 offen offset:1024 sc1
  buffer_load_dwordx4 v[128:131], v1, s[52:55], s50 offen offset:2048 sc1
  buffer_load_dwordx4 v[132:135], v1, s[52:55], s50 offen offset:3072 sc1
  s_add_u32 s50, s50, 8192
  buffer_load_dwordx4 v[136:139], v1, s[52:55], s50 offen offset:0 sc1
  buffer_load_dwordx4 v[140:143], v1, s[52:55], s50 offen offset:1024 sc1
  buffer_load_dwordx4 v[144:147], v1, s[52:55], s50 offen offset:2048 sc1
  buffer_load_dwordx4 v[148:151], v1, s[52:55], s50 offen offset:3072 sc1
  s_add_u32 s50, s50, 8192
  buffer_load_dwordx4 v[152:155], v1, s[52:55], s50 offen offset:0 sc1
  buffer_load_dwordx4 v[156:159], v1, s[52:55], s50 offen offset:1024 sc1
  s_mov_b64 exec, 1
  ds_add_u32 v2, v4 offset:108
  s_mov_b64 exec, -1
  s_waitcnt vmcnt(13)
  s_waitcnt lgkmcnt(7)
  v_mfma_f32_32x32x16_bf16 v[48:63], v[80:83], v[104:107], 0
  ds_read_b64_tr_b16 v[100:101], v7 offset:20480
  ds_read_b64_tr_b16 v[102:103], v7 offset:21504
  v_mfma_f32_32x32x16_bf16 v[32:47], v[84:87], v[104:107], v[32:47]
  ds_read_b64_tr_b16 v[80:81], v9 offset:22528
  ds_read_b64_tr_b16 v[82:83], v9 offset:23552
  buffer_load_dwordx4 v[104:107], v1, s[52:55], s50 offen offset:2048 sc1
  s_waitcnt vmcnt(13)
  s_waitcnt lgkmcnt(7)
  v_mfma_f32_32x32x16_bf16 v[48:63], v[88:91], v[108:111], v[48:63]
  ds_read_b64_tr_b16 v[84:85], v7 offset:22528
  ds_read_b64_tr_b16 v[86:87], v7 offset:23552
  v_mfma_f32_32x32x16_bf16 v[32:47], v[92:95], v[108:111], v[32:47]
  s_cmp_lt_u32 s66, 7
  s_cbranch_scc1 SL_15
SD_16:
  ds_read_b64_tr_b16 v[88:89], v9 offset:32768
  ds_read_b64_tr_b16 v[90:91], v9 offset:33792
  buffer_load_dwordx4 v[108:111], v1, s[52:55], s50 offen offset:3072 sc1
  s_waitcnt vmcnt(13)
  s_waitcnt lgkmcnt(6)
  v_mfma_f32_32x32x16_bf16 v[48:63], v[96:99], v[112:115], v[48:63]
  ds_read_b64_tr_b16 v[92:93], v7 offset:32768
  ds_read_b64_tr_b16 v[94:95], v7 offset:33792
  v_mfma_f32_32x32x16_bf16 v[32:47], v[100:103], v[112:115], v[32:47]
  ds_read_b64_tr_b16 v[96:97], v9 offset:34816
  ds_read_b64_tr_b16 v[98:99], v9 offset:35840
  s_waitcnt vmcnt(12)
  s_waitcnt lgkmcnt(6)
  v_mfma_f32_32x32x16_bf16 v[48:63], v[80:83], v[116:119], v[48:63]
  ds_read_b64_tr_b16 v[100:101], v7 offset:34816
  ds_read_b64_tr_b16 v[102:103], v7 offset:35840
  v_mfma_f32_32x32x16_bf16 v[32:47], v[84:87], v[116:119], v[32:47]
  ds_read_b64_tr_b16 v[80:81], v9 offset:36864
  ds_read_b64_tr_b16 v[82:83], v9 offset:37888
  s_waitcnt vmcnt(11)
  s_waitcnt lgkmcnt(6)
  v_mfma_f32_32x32x16_bf16 v[48:63], v[88:91], v[120:123], v[48:63]
  ds_read_b64_tr_b16 v[84:85], v7 offset:36864
  ds_read_b64_tr_b16 v[86:87], v7 offset:37888
  v_mfma_f32_32x32x16_bf16 v[32:47], v[92:95], v[120:123], v[32:47]
  ds_read_b64_tr_b16 v[88:89], v9 offset:38912
  ds_read_b64_tr_b16 v[90:91], v9 offset:39936
  s_waitcnt vmcnt(10)
  s_waitcnt lgkmcnt(6)
  v_mfma_f32_32x32x16_bf16 v[48:63], v[96:99], v[124:127], v[48:63]
  ds_read_b64_tr_b16 v[92:93], v7 offset:38912
  ds_read_b64_tr_b16 v[94:95], v7 offset:39936
  v_mfma_f32_32x32x16_bf16 v[32:47], v[100:103], v[124:127], v[32:47]
  s_cmp_lt_u32 s66, 8
  s_cbranch_scc1 SL_18
SD_19:
  ds_read_b64_tr_b16 v[96:97], v8 offset:0
  ds_read_b64_tr_b16 v[98:99], v8 offset:1024
  s_waitcnt vmcnt(9)
  s_waitcnt lgkmcnt(6)
  v_mfma_f32_32x32x16_bf16 v[48:63], v[80:83], v[128:131], v[48:63]
  ds_read_b64_tr_b16 v[100:101], v6 offset:0
  ds_read_b64_tr_b16 v[102:103], v6 offset:1024
  v_mfma_f32_32x32x16_bf16 v[32:47], v[84:87], v[128:131], v[32:47]
  ds_read_b64_tr_b16 v[80:81], v8 offset:2048
  ds_read_b64_tr_b16 v[82:83], v8 offset:3072
  s_waitcnt vmcnt(8)
  s_waitcnt lgkmcnt(6)
  v_mfma_f32_32x32x16_bf16 v[48:63], v[88:91], v[132:135], v[48:63]
  ds_read_b64_tr_b16 v[84:85], v6 offset:2048
  ds_read_b64_tr_b16 v[86:87], v6 offset:3072
  v_mfma_f32_32x32x16_bf16 v[32:47], v[92:95], v[132:135], v[32:47]
  ds_read_b64_tr_b16 v[88:89], v8 offset:4096
  ds_read_b64_tr_b16 v[90:91], v8 offset:5120
  s_waitcnt vmcnt(7)
  s_waitcnt lgkmcnt(6)
  v_mfma_f32_32x32x16_bf16 v[48:63], v[96:99], v[136:139], v[48:63]
  ds_read_b64_tr_b16 v[92:93], v8 offset:6144
  ds_read_b64_tr_b16 v[94:95], v8 offset:7168
  v_mfma_f32_32x32x16_bf16 v[32:47], v[100:103], v[136:139], v[32:47]
  s_cmp_lt_u32 s66, 9
  s_cbranch_scc1 SL_21
SD_22:
  ds_read_b64_tr_b16 v[96:97], v8 offset:16384
  ds_read_b64_tr_b16 v[98:99], v8 offset:17408
  s_waitcnt vmcnt(6)
  s_waitcnt lgkmcnt(6)
  v_mfma_f32_32x32x16_bf16 v[48:63], v[80:83], v[140:143], v[48:63]
  ds_read_b64_tr_b16 v[100:101], v8 offset:18432
  ds_read_b64_tr_b16 v[102:103], v8 offset:19456
  v_mfma_f32_32x32x16_bf16 v[32:47], v[84:87], v[140:143], v[32:47]
  ds_read_b64_tr_b16 v[80:81], v8 offset:20480
  ds_read_b64_tr_b16 v[82:83], v8 offset:21504
  s_waitcnt vmcnt(4)
  s_waitcnt lgkmcnt(6)
  v_mfma_f32_32x32x16_bf16 v[48:63], v[88:91], v[144:147], v[48:63]
  ds_read_b64_tr_b16 v[84:85], v8 offset:22528
  ds_read_b64_tr_b16 v[86:87], v8 offset:23552
  ds_write_b32 v3, v4 offset:144
  v_mfma_f32_32x32x16_bf16 v[48:63], v[92:95], v[148:151], v[48:63]
  ds_read_b64_tr_b16 v[88:89], v6 offset:4096
  ds_read_b64_tr_b16 v[90:91], v6 offset:5120
  ds_read_b128 v[10:13], v2
  s_waitcnt vmcnt(2)
  s_waitcnt lgkmcnt(8)
  v_mfma_f32_32x32x16_bf16 v[48:63], v[96:99], v[152:155], v[48:63]
  ds_read_b64_tr_b16 v[92:93], v6 offset:6144
  ds_read_b64_tr_b16 v[94:95], v6 offset:7168
  v_mfma_f32_32x32x16_bf16 v[48:63], v[100:103], v[156:159], v[48:63]
  ds_read_b64_tr_b16 v[96:97], v6 offset:16384
  ds_read_b64_tr_b16 v[98:99], v6 offset:17408
  s_waitcnt vmcnt(0)
  s_waitcnt lgkmcnt(8)
  v_mfma_f32_32x32x16_bf16 v[48:63], v[80:83], v[104:107], v[48:63]
  ds_read_b64_tr_b16 v[100:101], v6 offset:18432
  ds_read_b64_tr_b16 v[102:103], v6 offset:19456
  s_waitcnt lgkmcnt(6)
  v_min3_u32 v10, v10, v11, v12
  v_min_u32 v10, v10, v13
  s_nop 0
  v_readfirstlane_b32 s66, v10
  v_mfma_f32_32x32x16_bf16 v[48:63], v[84:87], v[108:111], v[48:63]
  ds_read_b64_tr_b16 v[80:81], v6 offset:20480
  ds_read_b64_tr_b16 v[82:83], v6 offset:21504
  s_waitcnt lgkmcnt(6)
  v_mfma_f32_32x32x16_bf16 v[32:47], v[88:91], v[144:147], v[32:47]
  ds_read_b64_tr_b16 v[84:85], v6 offset:22528
  ds_read_b64_tr_b16 v[86:87], v6 offset:23552
  v_add_u32 v23, 32768, v19
  s_cmp_lt_u32 s66, 10
  s_cbranch_scc1 SL_24
SD_25:
  v_mfma_f32_32x32x16_bf16 v[32:47], v[92:95], v[148:151], v[32:47]
  s_nop 1
  ds_write_b128 v23, v[48:51] offset:0
  ds_write_b128 v23, v[52:55] offset:1024
  s_waitcnt lgkmcnt(6)
  v_mfma_f32_32x32x16_bf16 v[32:47], v[96:99], v[152:155], v[32:47]
  ds_write_b128 v23, v[56:59] offset:2048
  ds_write_b128 v23, v[60:63] offset:3072
  v_mov_b32 v22, 2
  ds_write_b32 v3, v22 offset:64
  v_mfma_f32_32x32x16_bf16 v[32:47], v[100:103], v[156:159], v[32:47]
  s_waitcnt lgkmcnt(5)
  v_mfma_f32_32x32x16_bf16 v[32:47], v[80:83], v[104:107], v[32:47]
  v_mfma_f32_32x32x16_bf16 v[32:47], v[84:87], v[108:111], v[32:47]
  v_xor_b32 v23, 0x1000, v23
  v_xor_b32 v96, 4, v3
  ds_read_b32 v97, v96 offset:64
  ds_read_b128 v[80:83], v23 offset:0
  ds_read_b128 v[84:87], v23 offset:1024
  ds_read_b128 v[88:91], v23 offset:2048
  ds_read_b128 v[92:95], v23 offset:3072
  s_waitcnt lgkmcnt(0)
  v_cmp_gt_u32 vcc, 2, v97
  s_cbranch_vccz SD_28
SL_27:
  s_sub_u32 s68, s68, 1
  s_cbranch_scc1 ST_29
  s_nop 0
  ds_read_b32 v97, v96 offset:64
  ds_read_b128 v[80:83], v23 offset:0
  ds_read_b128 v[84:87], v23 offset:1024
  ds_read_b128 v[88:91], v23 offset:2048
  ds_read_b128 v[92:95], v23 offset:3072
  s_waitcnt lgkmcnt(0)
  v_cmp_gt_u32 vcc, 2, v97
  s_cbranch_vccnz SL_27
SD_28:
  v_mov_b32 v22, 10
  ds_write_b32 v3, v22 offset:16
  v_pk_add_f32 v[32:33], v[32:33], v[80:81]
  v_pk_add_f32 v[34:35], v[34:35], v[82:83]
  v_pk_add_f32 v[36:37], v[36:37], v[84:85]
  v_pk_add_f32 v[38:39], v[38:39], v[86:87]
  v_pk_add_f32 v[40:41], v[40:41], v[88:89]
  v_pk_add_f32 v[42:43], v[42:43], v[90:91]
  v_pk_add_f32 v[44:45], v[44:45], v[92:93]
  v_pk_add_f32 v[46:47], v[46:47], v[94:95]
  v_cvt_pk_bf16_f32 v24, v32, v33
  v_cvt_pk_bf16_f32 v25, v34, v35
  v_cvt_pk_bf16_f32 v26, v36, v37
  v_cvt_pk_bf16_f32 v27, v38, v39
  v_cvt_pk_bf16_f32 v28, v40, v41
  v_cvt_pk_bf16_f32 v29, v42, v43
  v_cvt_pk_bf16_f32 v30, v44, v45
  v_cvt_pk_bf16_f32 v31, v46, v47
  buffer_store_dwordx4 v[24:27], v1, s[52:55], s14 offen offset:0 sc1
  buffer_store_dwordx4 v[28:31], v1, s[52:55], s14 offen offset:1024 sc1
  v_pk_add_f32 v[124:125], v[32:33], v[34:35]
  v_pk_mul_f32 v[126:127], v[32:33], v[32:33]
  v_pk_fma_f32 v[126:127], v[34:35], v[34:35], v[126:127]
  v_pk_add_f32 v[124:125], v[124:125], v[36:37]
  v_pk_fma_f32 v[126:127], v[36:37], v[36:37], v[126:127]
  v_pk_add_f32 v[124:125], v[124:125], v[38:39]
  v_pk_fma_f32 v[126:127], v[38:39], v[38:39], v[126:127]
  v_pk_add_f32 v[124:125], v[124:125], v[40:41]
  v_pk_fma_f32 v[126:127], v[40:41], v[40:41], v[126:127]
  v_pk_add_f32 v[124:125], v[124:125], v[42:43]
  v_pk_fma_f32 v[126:127], v[42:43], v[42:43], v[126:127]
  v_pk_add_f32 v[124:125], v[124:125], v[44:45]
  v_pk_fma_f32 v[126:127], v[44:45], v[44:45], v[126:127]
  v_pk_add_f32 v[124:125], v[124:125], v[46:47]
  v_pk_fma_f32 v[126:127], v[46:47], v[46:47], v[126:127]
  v_add_f32 v124, v124, v125
  v_add_f32 v125, v126, v127
  s_nop 1
  v_permlane32_swap_b32 v124, v125
  v_add_f32 v124, v124, v125
  v_mov_b32 v22, 0
  ds_write_b32 v3, v22 offset:144
  buffer_store_dword v124, v66, s[52:55], s75 offen sc1
  s_waitcnt vmcnt(0)
  s_cmp_eq_u32 s13, 1
  s_cbranch_scc0 PS_30
  buffer_store_dword v15, off, s[52:55], s51 offset:256
PB_31:
  v_lshrrev_b32 v22, 5, v0
  v_bfe_u32 v23, v0, 2, 2
  v_lshl_add_u32 v8, v22, 2, v23
  v_lshlrev_b32 v8, 6, v8
  v_bfe_u32 v22, v0, 4, 1
  v_lshl_add_u32 v8, v22, 5, v8
  v_and_b32 v22, 3, v0
  v_lshl_add_u32 v8, v22, 3, v8
  v_add_u32 v9, 0x10000, v8
  s_and_b32 s72, s4, 30
  s_add_u32 s72, s72, s10
  s_mul_i32 s72, s72, 324608
  s_lshl_b32 s64, s12, 7
  s_add_u32 s64, s64, s72
  s_add_u32 s64, s64, 315392
  s_lshl2_add_u32 s65, s67, s64
  s_mul_i32 s73, s12, 153600
  s_add_u32 s72, s72, s73
  s_add_u32 s50, s72, 32768
  s_lshl_b32 s73, s67, 11
  s_add_u32 s14, s72, s73
  s_add_u32 s14, s14, 65536
  v_and_b32 v17, 15, v0
  v_lshlrev_b32 v17, 2, v17
  ds_read_b128 v[10:13], v2
  s_waitcnt lgkmcnt(0)
  v_min3_u32 v10, v10, v11, v12
  v_min_u32 v10, v10, v13
  s_nop 0
  v_readfirstlane_b32 s66, v10
  s_cmp_lt_u32 s66, 11
  s_cbranch_scc1 SL_32
SD_33:
  ds_read_b64_tr_b16 v[80:81], v8 offset:49152
  ds_read_b64_tr_b16 v[82:83], v8 offset:49664
  s_cmp_lt_u32 s66, 12
  s_cbranch_scc1 SL_35
SD_36:
  ds_read_b64_tr_b16 v[84:85], v9 offset:0
  ds_read_b64_tr_b16 v[86:87], v9 offset:512
  s_cmp_lt_u32 s66, 13
  s_cbranch_scc1 SL_38
SD_39:
  ds_read_b64_tr_b16 v[88:89], v9 offset:16384
  ds_read_b64_tr_b16 v[90:91], v9 offset:16896
  ds_read_b64_tr_b16 v[92:93], v8 offset:50176
  ds_read_b64_tr_b16 v[94:95], v8 offset:50688
  ds_read_b64_tr_b16 v[96:97], v9 offset:1024
  ds_read_b64_tr_b16 v[98:99], v9 offset:1536
  s_lshl_b32 s72, s67, 11
  s_add_u32 s72, s72, s50
SL_41:
  buffer_load_dword v23, v17, s[52:55], s64 offen offset:256 sc1
  s_waitcnt vmcnt(0)
  v_cmp_ne_u32 vcc, v15, v23
  s_cbranch_vccz SD_42
  s_sub_u32 s68, s68, 1
  s_cbranch_scc0 SL_41
  s_mov_b32 s68, 0
SD_42:
  buffer_load_dwordx4 v[104:107], v1, s[52:55], s50 offen offset:0 sc1
  buffer_load_dwordx4 v[108:111], v1, s[52:55], s50 offen offset:1024 sc1
  buffer_load_dwordx4 v[112:115], v1, s[52:55], s50 offen offset:2048 sc1
  buffer_load_dwordx4 v[116:119], v1, s[52:55], s50 offen offset:3072 sc1
  s_add_u32 s50, s50, 4096
  buffer_load_dwordx4 v[120:123], v1, s[52:55], s50 offen offset:0 sc1
  buffer_load_dwordx4 v[124:127], v1, s[52:55], s50 offen offset:1024 sc1
  buffer_load_dwordx4 v[128:131], v1, s[52:55], s50 offen offset:2048 sc1
  buffer_load_dwordx4 v[132:135], v1, s[52:55], s50 offen offset:3072 sc1
  s_waitcnt vmcnt(7)
  s_waitcnt lgkmcnt(6)
  v_mfma_f32_32x32x16_bf16 v[32:47], v[80:83], v[104:107], 0
  ds_read_b64_tr_b16 v[100:101], v9 offset:17408
  ds_read_b64_tr_b16 v[102:103], v9 offset:17920
  ds_write_b32 v3, v4 offset:192
  v_mfma_f32_32x32x16_bf16 v[48:63], v[84:87], v[104:107], 0
  ds_read_b64_tr_b16 v[80:81], v8 offset:51200
  ds_read_b64_tr_b16 v[82:83], v8 offset:51712
  s_add_u32 s50, s50, 4096
  buffer_load_dwordx4 v[136:139], v1, s[52:55], s50 offen offset:0 sc1
  s_waitcnt vmcnt(7)
  s_waitcnt lgkmcnt(7)
  v_mfma_f32_32x32x16_bf16 v[64:79], v[88:91], v[104:107], 0
  ds_read_b64_tr_b16 v[84:85], v9 offset:2048
  ds_read_b64_tr_b16 v[86:87], v9 offset:2560
  v_mfma_f32_32x32x16_bf16 v[32:47], v[92:95], v[108:111], v[32:47]
  ds_read_b64_tr_b16 v[88:89], v9 offset:18432
  ds_read_b64_tr_b16 v[90:91], v9 offset:18944
  buffer_load_dwordx4 v[140:143], v1, s[52:55], s50 offen offset:1024 sc1
  s_waitcnt lgkmcnt(7)
  v_mfma_f32_32x32x16_bf16 v[48:63], v[96:99], v[108:111], v[48:63]
  ds_read_b64_tr_b16 v[92:93], v8 offset:52224
  ds_read_b64_tr_b16 v[94:95], v8 offset:52736
  v_mfma_f32_32x32x16_bf16 v[64:79], v[100:103], v[108:111], v[64:79]
  ds_read_b64_tr_b16 v[96:97], v9 offset:3072
  ds_read_b64_tr_b16 v[98:99], v9 offset:3584
  buffer_load_dwordx4 v[144:147], v1, s[52:55], s50 offen offset:2048 sc1
  s_waitcnt vmcnt(8)
  s_waitcnt lgkmcnt(6)
  v_mfma_f32_32x32x16_bf16 v[32:47], v[80:83], v[112:115], v[32:47]
  ds_read_b64_tr_b16 v[100:101], v9 offset:19456
  ds_read_b64_tr_b16 v[102:103], v9 offset:19968
  v_mfma_f32_32x32x16_bf16 v[48:63], v[84:87], v[112:115], v[48:63]
  ds_read_b64_tr_b16 v[80:81], v8 offset:53248
  ds_read_b64_tr_b16 v[82:83], v8 offset:53760
  buffer_load_dwordx4 v[148:151], v1, s[52:55], s50 offen offset:3072 sc1
  s_waitcnt vmcnt(8)
  s_waitcnt lgkmcnt(6)
  v_mfma_f32_32x32x16_bf16 v[64:79], v[88:91], v[112:115], v[64:79]
  ds_read_b64_tr_b16 v[84:85], v9 offset:4096
  ds_read_b64_tr_b16 v[86:87], v9 offset:4608
  v_mfma_f32_32x32x16_bf16 v[32:47], v[92:95], v[116:119], v[32:47]
  ds_read_b64_tr_b16 v[88:89], v9 offset:20480
  ds_read_b64_tr_b16 v[90:91], v9 offset:20992
  s_add_u32 s50, s50, 4096
  buffer_load_dwordx4 v[152:155], v1, s[52:55], s50 offen offset:0 sc1
  s_waitcnt lgkmcnt(6)
  v_mfma_f32_32x32x16_bf16 v[48:63], v[96:99], v[116:119], v[48:63]
  ds_read_b64_tr_b16 v[92:93], v8 offset:54272
  ds_read_b64_tr_b16 v[94:95], v8 offset:54784
  v_mfma_f32_32x32x16_bf16 v[64:79], v[100:103], v[116:119], v[64:79]
  ds_read_b64_tr_b16 v[96:97], v9 offset:5120
  ds_read_b64_tr_b16 v[98:99], v9 offset:5632
  buffer_load_dwordx4 v[156:159], v1, s[52:55], s50 offen offset:1024 sc1
  s_waitcnt vmcnt(9)
  s_waitcnt lgkmcnt(6)
  v_mfma_f32_32x32x16_bf16 v[32:47], v[80:83], v[120:123], v[32:47]
  ds_read_b64_tr_b16 v[100:101], v9 offset:21504
  ds_read_b64_tr_b16 v[102:103], v9 offset:22016
  v_mfma_f32_32x32x16_bf16 v[48:63], v[84:87], v[120:123], v[48:63]
  ds_read_b64_tr_b16 v[80:81], v8 offset:55296
  ds_read_b64_tr_b16 v[82:83], v8 offset:55808
  buffer_load_dwordx4 v[104:107], v1, s[52:55], s50 offen offset:2048 sc1
  s_waitcnt vmcnt(9)
  s_waitcnt lgkmcnt(6)
  v_mfma_f32_32x32x16_bf16 v[64:79], v[88:91], v[120:123], v[64:79]
  ds_read_b64_tr_b16 v[84:85], v9 offset:6144
  ds_read_b64_tr_b16 v[86:87], v9 offset:6656
  v_mfma_f32_32x32x16_bf16 v[32:47], v[92:95], v[124:127], v[32:47]
  ds_read_b64_tr_b16 v[88:89], v9 offset:22528
  ds_read_b64_tr_b16 v[90:91], v9 offset:23040
  buffer_load_dwordx4 v[108:111], v1, s[52:55], s50 offen offset:3072 sc1
  s_waitcnt lgkmcnt(6)
  v_mfma_f32_32x32x16_bf16 v[48:63], v[96:99], v[124:127], v[48:63]
  ds_read_b64_tr_b16 v[92:93], v8 offset:56320
  ds_read_b64_tr_b16 v[94:95], v8 offset:56832
  v_mfma_f32_32x32x16_bf16 v[64:79], v[100:103], v[124:127], v[64:79]
  ds_read_b64_tr_b16 v[96:97], v9 offset:7168
  ds_read_b64_tr_b16 v[98:99], v9 offset:7680
  s_add_u32 s50, s50, 4096
  buffer_load_dwordx4 v[112:115], v1, s[52:55], s50 offen offset:0 sc1
  s_waitcnt vmcnt(10)
  s_waitcnt lgkmcnt(6)
  v_mfma_f32_32x32x16_bf16 v[32:47], v[80:83], v[128:131], v[32:47]
  ds_read_b64_tr_b16 v[100:101], v9 offset:23552
  ds_read_b64_tr_b16 v[102:103], v9 offset:24064
  v_mfma_f32_32x32x16_bf16 v[48:63], v[84:87], v[128:131], v[48:63]
  ds_read_b64_tr_b16 v[80:81], v8 offset:57344
  ds_read_b64_tr_b16 v[82:83], v8 offset:57856
  buffer_load_dwordx4 v[116:119], v1, s[52:55], s50 offen offset:1024 sc1
  s_waitcnt vmcnt(10)
  s_waitcnt lgkmcnt(6)
  v_mfma_f32_32x32x16_bf16 v[64:79], v[88:91], v[128:131], v[64:79]
  ds_read_b64_tr_b16 v[84:85], v9 offset:8192
  ds_read_b64_tr_b16 v[86:87], v9 offset:8704
  v_mfma_f32_32x32x16_bf16 v[32:47], v[92:95], v[132:135], v[32:47]
  ds_read_b64_tr_b16 v[88:89], v9 offset:24576
  ds_read_b64_tr_b16 v[90:91], v9 offset:25088
  buffer_load_dwordx4 v[120:123], v1, s[52:55], s50 offen offset:2048 sc1
  s_waitcnt lgkmcnt(6)
  v_mfma_f32_32x32x16_bf16 v[48:63], v[96:99], v[132:135], v[48:63]
  ds_read_b64_tr_b16 v[92:93], v8 offset:58368
  ds_read_b64_tr_b16 v[94:95], v8 offset:58880
  v_mfma_f32_32x32x16_bf16 v[64:79], v[100:103], v[132:135], v[64:79]
  ds_read_b64_tr_b16 v[96:97], v9 offset:9216
  ds_read_b64_tr_b16 v[98:99], v9 offset:9728
  buffer_load_dwordx4 v[124:127], v1, s[52:55], s50 offen offset:3072 sc1
  s_waitcnt vmcnt(11)
  s_waitcnt lgkmcnt(6)
  v_mfma_f32_32x32x16_bf16 v[32:47], v[80:83], v[136:139], v[32:47]
  ds_read_b64_tr_b16 v[100:101], v9 offset:25600
  ds_read_b64_tr_b16 v[102:103], v9 offset:26112
  v_mfma_f32_32x32x16_bf16 v[48:63], v[84:87], v[136:139], v[48:63]
  ds_read_b64_tr_b16 v[80:81], v8 offset:59392
  ds_read_b64_tr_b16 v[82:83], v8 offset:59904
  s_add_u32 s50, s50, 4096
  buffer_load_dwordx4 v[128:131], v1, s[52:55], s50 offen offset:0 sc1
  s_waitcnt vmcnt(11)
  s_waitcnt lgkmcnt(6)
  v_mfma_f32_32x32x16_bf16 v[64:79], v[88:91], v[136:139], v[64:79]
  ds_read_b64_tr_b16 v[84:85], v9 offset:10240
  ds_read_b64_tr_b16 v[86:87], v9 offset:10752
  v_mfma_f32_32x32x16_bf16 v[32:47], v[92:95], v[140:143], v[32:47]
  ds_read_b64_tr_b16 v[88:89], v9 offset:26624
  ds_read_b64_tr_b16 v[90:91], v9 offset:27136
  buffer_load_dwordx4 v[132:135], v1, s[52:55], s50 offen offset:1024 sc1
  s_waitcnt lgkmcnt(6)
  v_mfma_f32_32x32x16_bf16 v[48:63], v[96:99], v[140:143], v[48:63]
  ds_read_b64_tr_b16 v[92:93], v8 offset:60416
  ds_read_b64_tr_b16 v[94:95], v8 offset:60928
  v_mfma_f32_32x32x16_bf16 v[64:79], v[100:103], v[140:143], v[64:79]
  ds_read_b64_tr_b16 v[96:97], v9 offset:11264
  ds_read_b64_tr_b16 v[98:99], v9 offset:11776
  buffer_load_dwordx4 v[136:139], v1, s[52:55], s50 offen offset:2048 sc1
  s_waitcnt vmcnt(12)
  s_waitcnt lgkmcnt(6)
  v_mfma_f32_32x32x16_bf16 v[32:47], v[80:83], v[144:147], v[32:47]
  ds_read_b64_tr_b16 v[100:101], v9 offset:27648
  ds_read_b64_tr_b16 v[102:103], v9 offset:28160
  v_mfma_f32_32x32x16_bf16 v[48:63], v[84:87], v[144:147], v[48:63]
  ds_read_b64_tr_b16 v[80:81], v8 offset:61440
  ds_read_b64_tr_b16 v[82:83], v8 offset:61952
  buffer_load_dwordx4 v[140:143], v1, s[52:55], s50 offen offset:3072 sc1
  s_waitcnt vmcnt(12)
  s_waitcnt lgkmcnt(6)
  v_mfma_f32_32x32x16_bf16 v[64:79], v[88:91], v[144:147], v[64:79]
  ds_read_b64_tr_b16 v[84:85], v9 offset:12288
  ds_read_b64_tr_b16 v[86:87], v9 offset:12800
  v_mfma_f32_32x32x16_bf16 v[32:47], v[92:95], v[148:151], v[32:47]
  ds_read_b64_tr_b16 v[88:89], v9 offset:28672
  ds_read_b64_tr_b16 v[90:91], v9 offset:29184
  s_add_u32 s50, s50, 4096
  buffer_load_dwordx4 v[144:147], v1, s[52:55], s50 offen offset:0 sc1
  s_waitcnt lgkmcnt(6)
  v_mfma_f32_32x32x16_bf16 v[48:63], v[96:99], v[148:151], v[48:63]
  ds_read_b64_tr_b16 v[92:93], v8 offset:62464
  ds_read_b64_tr_b16 v[94:95], v8 offset:62976
  v_mfma_f32_32x32x16_bf16 v[64:79], v[100:103], v[148:151], v[64:79]
  ds_read_b64_tr_b16 v[96:97], v9 offset:13312
  ds_read_b64_tr_b16 v[98:99], v9 offset:13824
  buffer_load_dwordx4 v[148:151], v1, s[52:55], s50 offen offset:1024 sc1
  s_waitcnt vmcnt(13)
  s_waitcnt lgkmcnt(6)
  v_mfma_f32_32x32x16_bf16 v[32:47], v[80:83], v[152:155], v[32:47]
  ds_read_b64_tr_b16 v[100:101], v9 offset:29696
  ds_read_b64_tr_b16 v[102:103], v9 offset:30208
  s_mov_b64 exec, 1
  ds_add_u32 v2, v4 offset:108
  s_mov_b64 exec, -1
  v_mfma_f32_32x32x16_bf16 v[48:63], v[84:87], v[152:155], v[48:63]
  ds_read_b64_tr_b16 v[80:81], v8 offset:63488
  ds_read_b64_tr_b16 v[82:83], v8 offset:64000
  ds_read_b128 v[10:13], v2
  s_waitcnt vmcnt(12)
  s_waitcnt lgkmcnt(8)
  v_mfma_f32_32x32x16_bf16 v[64:79], v[88:91], v[152:155], v[64:79]
  ds_read_b64_tr_b16 v[84:85], v9 offset:14336
  ds_read_b64_tr_b16 v[86:87], v9 offset:14848
  buffer_load_dwordx4 v[152:155], v1, s[52:55], s50 offen offset:2048 sc1
  v_mfma_f32_32x32x16_bf16 v[32:47], v[92:95], v[156:159], v[32:47]
  ds_read_b64_tr_b16 v[88:89], v9 offset:30720
  ds_read_b64_tr_b16 v[90:91], v9 offset:31232
  s_waitcnt lgkmcnt(8)
  v_mfma_f32_32x32x16_bf16 v[48:63], v[96:99], v[156:159], v[48:63]
  ds_read_b64_tr_b16 v[92:93], v8 offset:64512
  ds_read_b64_tr_b16 v[94:95], v8 offset:65024
  v_mfma_f32_32x32x16_bf16 v[64:79], v[100:103], v[156:159], v[64:79]
  ds_read_b64_tr_b16 v[96:97], v9 offset:15360
  ds_read_b64_tr_b16 v[98:99], v9 offset:15872
  s_waitcnt lgkmcnt(8)
  v_min3_u32 v10, v10, v11, v12
  v_min_u32 v10, v10, v13
  s_nop 0
  v_readfirstlane_b32 s66, v10
  buffer_load_dwordx4 v[156:159], v1, s[52:55], s50 offen offset:3072 sc1
  s_waitcnt vmcnt(13)
  s_waitcnt lgkmcnt(6)
  v_mfma_f32_32x32x16_bf16 v[32:47], v[80:83], v[104:107], v[32:47]
  ds_read_b64_tr_b16 v[100:101], v9 offset:31744
  ds_read_b64_tr_b16 v[102:103], v9 offset:32256
  v_mfma_f32_32x32x16_bf16 v[48:63], v[84:87], v[104:107], v[48:63]
  s_cmp_lt_u32 s66, 14
  s_cbranch_scc1 SL_44
SD_45:
  ds_read_b64_tr_b16 v[80:81], v9 offset:32768
  ds_read_b64_tr_b16 v[82:83], v9 offset:33280
  s_waitcnt vmcnt(12)
  s_waitcnt lgkmcnt(6)
  v_mfma_f32_32x32x16_bf16 v[64:79], v[88:91], v[104:107], v[64:79]
  s_cmp_lt_u32 s66, 15
  s_cbranch_scc1 SL_47
SD_48:
  s_nop 0
  ds_read_b64_tr_b16 v[84:85], v8 offset:0
  ds_read_b64_tr_b16 v[86:87], v8 offset:512
  s_add_u32 s50, s50, 4096
  buffer_load_dwordx4 v[104:107], v1, s[52:55], s50 offen offset:0 sc1
  v_mfma_f32_32x32x16_bf16 v[32:47], v[92:95], v[108:111], v[32:47]
  s_cmp_lt_u32 s66, 16
  s_cbranch_scc1 SL_50
SD_51:
  ds_read_b64_tr_b16 v[88:89], v8 offset:16384
  ds_read_b64_tr_b16 v[90:91], v8 offset:16896
  s_waitcnt lgkmcnt(6)
  v_mfma_f32_32x32x16_bf16 v[48:63], v[96:99], v[108:111], v[48:63]
  ds_read_b64_tr_b16 v[92:93], v9 offset:33792
  ds_read_b64_tr_b16 v[94:95], v9 offset:34304
  v_mfma_f32_32x32x16_bf16 v[64:79], v[100:103], v[108:111], v[64:79]
  ds_read_b64_tr_b16 v[96:97], v8 offset:1024
  ds_read_b64_tr_b16 v[98:99], v8 offset:1536
  buffer_load_dwordx4 v[108:111], v1, s[52:55], s50 offen offset:1024 sc1
  s_waitcnt vmcnt(13)
  s_waitcnt lgkmcnt(6)
  v_mfma_f32_32x32x16_bf16 v[32:47], v[80:83], v[112:115], v[32:47]
  ds_read_b64_tr_b16 v[100:101], v8 offset:17408
  ds_read_b64_tr_b16 v[102:103], v8 offset:17920
  v_mfma_f32_32x32x16_bf16 v[48:63], v[84:87], v[112:115], v[48:63]
  ds_read_b64_tr_b16 v[80:81], v9 offset:34816
  ds_read_b64_tr_b16 v[82:83], v9 offset:35328
  s_waitcnt vmcnt(12)
  s_waitcnt lgkmcnt(6)
  v_mfma_f32_32x32x16_bf16 v[64:79], v[88:91], v[112:115], v[64:79]
  ds_read_b64_tr_b16 v[84:85], v8 offset:2048
  ds_read_b64_tr_b16 v[86:87], v8 offset:2560
  buffer_load_dwordx4 v[112:115], v1, s[52:55], s50 offen offset:2048 sc1
  v_mfma_f32_32x32x16_bf16 v[32:47], v[92:95], v[116:119], v[32:47]
  ds_read_b64_tr_b16 v[88:89], v8 offset:18432
  ds_read_b64_tr_b16 v[90:91], v8 offset:18944
  s_waitcnt lgkmcnt(6)
  v_mfma_f32_32x32x16_bf16 v[48:63], v[96:99], v[116:119], v[48:63]
  ds_read_b64_tr_b16 v[92:93], v9 offset:35840
  ds_read_b64_tr_b16 v[94:95], v9 offset:36352
  v_mfma_f32_32x32x16_bf16 v[64:79], v[100:103], v[116:119], v[64:79]
  ds_read_b64_tr_b16 v[96:97], v8 offset:3072
  ds_read_b64_tr_b16 v[98:99], v8 offset:3584
  buffer_load_dwordx4 v[116:119], v1, s[52:55], s50 offen offset:3072 sc1
  s_waitcnt vmcnt(13)
  s_waitcnt lgkmcnt(6)
  v_mfma_f32_32x32x16_bf16 v[32:47], v[80:83], v[120:123], v[32:47]
  ds_read_b64_tr_b16 v[100:101], v8 offset:19456
  ds_read_b64_tr_b16 v[102:103], v8 offset:19968
  v_mfma_f32_32x32x16_bf16 v[48:63], v[84:87], v[120:123], v[48:63]
  ds_read_b64_tr_b16 v[80:81], v9 offset:36864
  ds_read_b64_tr_b16 v[82:83], v9 offset:37376
  s_waitcnt vmcnt(12)
  s_waitcnt lgkmcnt(6)
  v_mfma_f32_32x32x16_bf16 v[64:79], v[88:91], v[120:123], v[64:79]
  ds_read_b64_tr_b16 v[84:85], v8 offset:4096
  ds_read_b64_tr_b16 v[86:87], v8 offset:4608
  v_mfma_f32_32x32x16_bf16 v[32:47], v[92:95], v[124:127], v[32:47]
  ds_read_b64_tr_b16 v[88:89], v8 offset:20480
  ds_read_b64_tr_b16 v[90:91], v8 offset:20992
  s_waitcnt lgkmcnt(6)
  v_mfma_f32_32x32x16_bf16 v[48:63], v[96:99], v[124:127], v[48:63]
  ds_read_b64_tr_b16 v[92:93], v9 offset:37888
  ds_read_b64_tr_b16 v[94:95], v9 offset:38400
  v_mfma_f32_32x32x16_bf16 v[64:79], v[100:103], v[124:127], v[64:79]
  ds_read_b64_tr_b16 v[96:97], v8 offset:5120
  ds_read_b64_tr_b16 v[98:99], v8 offset:5632
  s_waitcnt vmcnt(11)
  s_waitcnt lgkmcnt(6)
  v_mfma_f32_32x32x16_bf16 v[32:47], v[80:83], v[128:131], v[32:47]
  ds_read_b64_tr_b16 v[100:101], v8 offset:21504
  ds_read_b64_tr_b16 v[102:103], v8 offset:22016
  s_lshl_b32 s72, s3, 7
  s_add_u32 s72, s72, 161664
  v_and_b32 v20, 31, v0
  v_lshl_add_u32 v20, v20, 2, s72
  v_lshrrev_b32 v21, 5, v0
  v_lshlrev_b32 v21, 4, v21
  v_add_u32 v21, 157696, v21
  v_mfma_f32_32x32x16_bf16 v[48:63], v[84:87], v[128:131], v[48:63]
  ds_read_b64_tr_b16 v[80:81], v9 offset:38912
  ds_read_b64_tr_b16 v[82:83], v9 offset:39424
  s_waitcnt vmcnt(10)
  s_waitcnt lgkmcnt(6)
  v_mfma_f32_32x32x16_bf16 v[64:79], v[88:91], v[128:131], v[64:79]
  ds_read_b64_tr_b16 v[84:85], v9 offset:39936
  ds_read_b64_tr_b16 v[86:87], v9 offset:40448
  v_mfma_f32_32x32x16_bf16 v[32:47], v[92:95], v[132:135], v[32:47]
  ds_read_b64_tr_b16 v[88:89], v9 offset:40960
  ds_read_b64_tr_b16 v[90:91], v9 offset:41472
  s_waitcnt lgkmcnt(6)
  v_mfma_f32_32x32x16_bf16 v[48:63], v[96:99], v[132:135], v[48:63]
  ds_read_b64_tr_b16 v[92:93], v9 offset:41984
  ds_read_b64_tr_b16 v[94:95], v9 offset:42496
  v_mfma_f32_32x32x16_bf16 v[64:79], v[100:103], v[132:135], v[64:79]
  ds_read_b64_tr_b16 v[96:97], v9 offset:43008
  ds_read_b64_tr_b16 v[98:99], v9 offset:43520
  s_waitcnt vmcnt(8)
  s_waitcnt lgkmcnt(6)
  v_mfma_f32_32x32x16_bf16 v[32:47], v[80:83], v[136:139], v[32:47]
  ds_read_b64_tr_b16 v[100:101], v9 offset:44032
  ds_read_b64_tr_b16 v[102:103], v9 offset:44544
  v_mfma_f32_32x32x16_bf16 v[32:47], v[84:87], v[140:143], v[32:47]
  ds_read_b64_tr_b16 v[80:81], v9 offset:45056
  ds_read_b64_tr_b16 v[82:83], v9 offset:45568
  s_waitcnt vmcnt(6)
  s_waitcnt lgkmcnt(6)
  v_mfma_f32_32x32x16_bf16 v[32:47], v[88:91], v[144:147], v[32:47]
  ds_read_b64_tr_b16 v[84:85], v9 offset:46080
  ds_read_b64_tr_b16 v[86:87], v9 offset:46592
  v_mfma_f32_32x32x16_bf16 v[32:47], v[92:95], v[148:151], v[32:47]
  ds_read_b64_tr_b16 v[88:89], v9 offset:47104
  ds_read_b64_tr_b16 v[90:91], v9 offset:47616
  s_waitcnt vmcnt(4)
  s_waitcnt lgkmcnt(6)
  v_mfma_f32_32x32x16_bf16 v[32:47], v[96:99], v[152:155], v[32:47]
  ds_read_b64_tr_b16 v[92:93], v9 offset:48128
  ds_read_b64_tr_b16 v[94:95], v9 offset:48640
  v_mfma_f32_32x32x16_bf16 v[32:47], v[100:103], v[156:159], v[32:47]
  ds_read_b64_tr_b16 v[96:97], v8 offset:6144
  ds_read_b64_tr_b16 v[98:99], v8 offset:6656
  s_waitcnt vmcnt(2)
  s_waitcnt lgkmcnt(6)
  v_mfma_f32_32x32x16_bf16 v[32:47], v[80:83], v[104:107], v[32:47]
  ds_read_b64_tr_b16 v[100:101], v8 offset:7168
  ds_read_b64_tr_b16 v[102:103], v8 offset:7680
  v_mov_b32_e64 v22, 14
  ds_write_b32 v3, v22 offset:16
  ds_read_b32 v10, v2 offset:36
  ds_read_b32 v11, v3 offset:160
  ds_read_b32 v14, v20
  ds_read_b32 v16, v20 offset:512
  ds_read_b128 v[120:123], v21 offset:0
  ds_read_b128 v[124:127], v21 offset:32
  ds_read_b128 v[128:131], v21 offset:64
  ds_read_b128 v[132:135], v21 offset:96
  v_mfma_f32_32x32x16_bf16 v[32:47], v[84:87], v[108:111], v[32:47]
  ds_read_b64_tr_b16 v[80:81], v8 offset:8192
  ds_read_b64_tr_b16 v[82:83], v8 offset:8704
  s_waitcnt vmcnt(0)
  s_waitcnt lgkmcnt(15)
  v_mfma_f32_32x32x16_bf16 v[32:47], v[88:91], v[112:115], v[32:47]
  ds_read_b64_tr_b16 v[84:85], v8 offset:9216
  ds_read_b64_tr_b16 v[86:87], v8 offset:9728
  v_mfma_f32_32x32x16_bf16 v[32:47], v[92:95], v[116:119], v[32:47]
  ds_read_b64_tr_b16 v[88:89], v8 offset:10240
  ds_read_b64_tr_b16 v[90:91], v8 offset:10752
  s_waitcnt lgkmcnt(15)
  v_mfma_f32_32x32x16_bf16 v[48:63], v[96:99], v[136:139], v[48:63]
  ds_read_b64_tr_b16 v[92:93], v8 offset:11264
  ds_read_b64_tr_b16 v[94:95], v8 offset:11776
  s_waitcnt lgkmcnt(0)
  v_min_u32 v10, v10, v11
  v_cmp_eq_u32 vcc, 0, v10
  s_cbranch_vccnz SL_53
SD_54:
  s_nop 1
  v_pk_fma_f32 v[32:33], v[120:121], v[14:15], v[32:33] op_sel_hi:[1,0,1]
  v_pk_fma_f32 v[34:35], v[122:123], v[14:15], v[34:35] op_sel_hi:[1,0,1]
  v_pk_fma_f32 v[36:37], v[124:125], v[14:15], v[36:37] op_sel_hi:[1,0,1]
  v_pk_fma_f32 v[38:39], v[126:127], v[14:15], v[38:39] op_sel_hi:[1,0,1]
  v_pk_fma_f32 v[40:41], v[128:129], v[14:15], v[40:41] op_sel_hi:[1,0,1]
  v_pk_fma_f32 v[42:43], v[130:131], v[14:15], v[42:43] op_sel_hi:[1,0,1]
  v_pk_fma_f32 v[44:45], v[132:133], v[14:15], v[44:45] op_sel_hi:[1,0,1]
  v_pk_fma_f32 v[46:47], v[134:135], v[14:15], v[46:47] op_sel_hi:[1,0,1]
  v_pk_mul_f32 v[32:33], v[32:33], v[16:17] op_sel_hi:[1,0]
  v_pk_mul_f32 v[34:35], v[34:35], v[16:17] op_sel_hi:[1,0]
  v_pk_mul_f32 v[36:37], v[36:37], v[16:17] op_sel_hi:[1,0]
  v_pk_mul_f32 v[38:39], v[38:39], v[16:17] op_sel_hi:[1,0]
  v_pk_mul_f32 v[40:41], v[40:41], v[16:17] op_sel_hi:[1,0]
  v_pk_mul_f32 v[42:43], v[42:43], v[16:17] op_sel_hi:[1,0]
  v_pk_mul_f32 v[44:45], v[44:45], v[16:17] op_sel_hi:[1,0]
  v_pk_mul_f32 v[46:47], v[46:47], v[16:17] op_sel_hi:[1,0]
  v_pk_mul_f32 v[120:121], v[32:33], v[32:33]
  v_pk_mul_f32 v[122:123], v[34:35], v[34:35]
  v_pk_mul_f32 v[124:125], v[36:37], v[36:37]
  v_pk_mul_f32 v[126:127], v[38:39], v[38:39]
  v_pk_mul_f32 v[128:129], v[40:41], v[40:41]
  v_pk_mul_f32 v[130:131], v[42:43], v[42:43]
  v_pk_mul_f32 v[132:133], v[44:45], v[44:45]
  v_pk_mul_f32 v[134:135], v[46:47], v[46:47]
  v_pk_fma_f32 v[120:121], v[120:121], s[70:71], v[18:19] op_sel_hi:[1,0,0]
  v_pk_fma_f32 v[122:123], v[122:123], s[70:71], v[18:19] op_sel_hi:[1,0,0]
  v_pk_fma_f32 v[124:125], v[124:125], s[70:71], v[18:19] op_sel_hi:[1,0,0]
  v_pk_fma_f32 v[126:127], v[126:127], s[70:71], v[18:19] op_sel_hi:[1,0,0]
  v_pk_fma_f32 v[128:129], v[128:129], s[70:71], v[18:19] op_sel_hi:[1,0,0]
  v_pk_fma_f32 v[130:131], v[130:131], s[70:71], v[18:19] op_sel_hi:[1,0,0]
  v_pk_fma_f32 v[132:133], v[132:133], s[70:71], v[18:19] op_sel_hi:[1,0,0]
  v_pk_fma_f32 v[134:135], v[134:135], s[70:71], v[18:19] op_sel_hi:[1,0,0]
  v_pk_mul_f32 v[120:121], v[120:121], v[32:33]
  v_pk_mul_f32 v[122:123], v[122:123], v[34:35]
  v_pk_mul_f32 v[124:125], v[124:125], v[36:37]
  v_pk_mul_f32 v[126:127], v[126:127], v[38:39]
  v_pk_mul_f32 v[128:129], v[128:129], v[40:41]
  v_pk_mul_f32 v[130:131], v[130:131], v[42:43]
  v_pk_mul_f32 v[132:133], v[132:133], v[44:45]
  v_pk_mul_f32 v[134:135], v[134:135], v[46:47]
  v_exp_f32 v120, v120
  v_exp_f32 v121, v121
  v_exp_f32 v122, v122
  v_exp_f32 v123, v123
  v_exp_f32 v124, v124
  v_exp_f32 v125, v125
  v_exp_f32 v126, v126
  v_exp_f32 v127, v127
  v_exp_f32 v128, v128
  v_exp_f32 v129, v129
  v_exp_f32 v130, v130
  v_exp_f32 v131, v131
  v_exp_f32 v132, v132
  v_exp_f32 v133, v133
  v_exp_f32 v134, v134
  v_exp_f32 v135, v135
  v_pk_add_f32 v[120:121], v[120:121], 1.0 op_sel_hi:[1,0]
  v_pk_add_f32 v[122:123], v[122:123], 1.0 op_sel_hi:[1,0]
  v_pk_add_f32 v[124:125], v[124:125], 1.0 op_sel_hi:[1,0]
  v_pk_add_f32 v[126:127], v[126:127], 1.0 op_sel_hi:[1,0]
  v_pk_add_f32 v[128:129], v[128:129], 1.0 op_sel_hi:[1,0]
  v_pk_add_f32 v[130:131], v[130:131], 1.0 op_sel_hi:[1,0]
  v_pk_add_f32 v[132:133], v[132:133], 1.0 op_sel_hi:[1,0]
  v_pk_add_f32 v[134:135], v[134:135], 1.0 op_sel_hi:[1,0]
  v_rcp_f32 v120, v120
  v_rcp_f32 v121, v121
  v_rcp_f32 v122, v122
  v_rcp_f32 v123, v123
  v_rcp_f32 v124, v124
  v_rcp_f32 v125, v125
  v_rcp_f32 v126, v126
  v_rcp_f32 v127, v127
  v_rcp_f32 v128, v128
  v_rcp_f32 v129, v129
  v_rcp_f32 v130, v130
  v_rcp_f32 v131, v131
  v_rcp_f32 v132, v132
  v_rcp_f32 v133, v133
  v_rcp_f32 v134, v134
  v_rcp_f32 v135, v135
  v_pk_mul_f32 v[32:33], v[120:121], v[32:33]
  v_pk_mul_f32 v[34:35], v[122:123], v[34:35]
  v_pk_mul_f32 v[36:37], v[124:125], v[36:37]
  v_pk_mul_f32 v[38:39], v[126:127], v[38:39]
  v_pk_mul_f32 v[40:41], v[128:129], v[40:41]
  v_pk_mul_f32 v[42:43], v[130:131], v[42:43]
  v_pk_mul_f32 v[44:45], v[132:133], v[44:45]
  v_pk_mul_f32 v[46:47], v[134:135], v[46:47]
  v_cvt_pk_bf16_f32 v120, v32, v33
  v_cvt_pk_bf16_f32 v121, v34, v35
  v_cvt_pk_bf16_f32 v122, v36, v37
  v_cvt_pk_bf16_f32 v123, v38, v39
  v_cvt_pk_bf16_f32 v124, v40, v41
  v_cvt_pk_bf16_f32 v125, v42, v43
  v_cvt_pk_bf16_f32 v126, v44, v45
  v_cvt_pk_bf16_f32 v127, v46, v47
  buffer_store_dwordx4 v[120:123], v1, s[52:55], s14 offen offset:0 sc1
  buffer_store_dwordx4 v[124:127], v1, s[52:55], s14 offen offset:1024 sc1
  s_add_u32 s14, s14, 0x8000
  ds_read_b128 v[32:35], v21 offset:128
  ds_read_b128 v[36:39], v21 offset:160
  ds_read_b128 v[40:43], v21 offset:192
  ds_read_b128 v[44:47], v21 offset:224
  v_mfma_f32_32x32x16_bf16 v[48:63], v[100:103], v[140:143], v[48:63]
  ds_read_b64_tr_b16 v[96:97], v8 offset:12288
  ds_read_b64_tr_b16 v[98:99], v8 offset:12800
  v_mfma_f32_32x32x16_bf16 v[48:63], v[80:83], v[144:147], v[48:63]
  ds_read_b64_tr_b16 v[100:101], v8 offset:13312
  ds_read_b64_tr_b16 v[102:103], v8 offset:13824
  v_mfma_f32_32x32x16_bf16 v[48:63], v[84:87], v[148:151], v[48:63]
  ds_read_b64_tr_b16 v[80:81], v8 offset:14336
  ds_read_b64_tr_b16 v[82:83], v8 offset:14848
  v_mfma_f32_32x32x16_bf16 v[48:63], v[88:91], v[152:155], v[48:63]
  ds_read_b64_tr_b16 v[84:85], v8 offset:15360
  ds_read_b64_tr_b16 v[86:87], v8 offset:15872
  v_mfma_f32_32x32x16_bf16 v[48:63], v[92:95], v[156:159], v[48:63]
  ds_read_b64_tr_b16 v[88:89], v8 offset:22528
  ds_read_b64_tr_b16 v[90:91], v8 offset:23040
  s_waitcnt lgkmcnt(6)
  v_mfma_f32_32x32x16_bf16 v[48:63], v[96:99], v[104:107], v[48:63]
  ds_read_b64_tr_b16 v[92:93], v8 offset:23552
  ds_read_b64_tr_b16 v[94:95], v8 offset:24064
  v_mov_b32 v22, 15
  ds_write_b32 v3, v22 offset:16
  v_mfma_f32_32x32x16_bf16 v[48:63], v[100:103], v[108:111], v[48:63]
  ds_read_b64_tr_b16 v[96:97], v8 offset:24576
  ds_read_b64_tr_b16 v[98:99], v8 offset:25088
  s_waitcnt lgkmcnt(7)
  v_mfma_f32_32x32x16_bf16 v[48:63], v[80:83], v[112:115], v[48:63]
  ds_read_b64_tr_b16 v[100:101], v8 offset:25600
  ds_read_b64_tr_b16 v[102:103], v8 offset:26112
  v_mfma_f32_32x32x16_bf16 v[48:63], v[84:87], v[116:119], v[48:63]
  ds_read_b64_tr_b16 v[80:81], v8 offset:26624
  ds_read_b64_tr_b16 v[82:83], v8 offset:27136
  s_waitcnt lgkmcnt(7)
  v_mfma_f32_32x32x16_bf16 v[64:79], v[88:91], v[136:139], v[64:79]
  ds_read_b64_tr_b16 v[84:85], v8 offset:27648
  ds_read_b64_tr_b16 v[86:87], v8 offset:28160
  s_nop 5
  s_nop 0
  v_pk_fma_f32 v[48:49], v[32:33], v[14:15], v[48:49] op_sel_hi:[1,0,1]
  v_pk_fma_f32 v[50:51], v[34:35], v[14:15], v[50:51] op_sel_hi:[1,0,1]
  v_pk_fma_f32 v[52:53], v[36:37], v[14:15], v[52:53] op_sel_hi:[1,0,1]
  v_pk_fma_f32 v[54:55], v[38:39], v[14:15], v[54:55] op_sel_hi:[1,0,1]
  v_pk_fma_f32 v[56:57], v[40:41], v[14:15], v[56:57] op_sel_hi:[1,0,1]
  v_pk_fma_f32 v[58:59], v[42:43], v[14:15], v[58:59] op_sel_hi:[1,0,1]
  v_pk_fma_f32 v[60:61], v[44:45], v[14:15], v[60:61] op_sel_hi:[1,0,1]
  v_pk_fma_f32 v[62:63], v[46:47], v[14:15], v[62:63] op_sel_hi:[1,0,1]
  v_pk_mul_f32 v[48:49], v[48:49], v[16:17] op_sel_hi:[1,0]
  v_pk_mul_f32 v[50:51], v[50:51], v[16:17] op_sel_hi:[1,0]
  v_pk_mul_f32 v[52:53], v[52:53], v[16:17] op_sel_hi:[1,0]
  v_pk_mul_f32 v[54:55], v[54:55], v[16:17] op_sel_hi:[1,0]
  v_pk_mul_f32 v[56:57], v[56:57], v[16:17] op_sel_hi:[1,0]
  v_pk_mul_f32 v[58:59], v[58:59], v[16:17] op_sel_hi:[1,0]
  v_pk_mul_f32 v[60:61], v[60:61], v[16:17] op_sel_hi:[1,0]
  v_pk_mul_f32 v[62:63], v[62:63], v[16:17] op_sel_hi:[1,0]
  v_pk_mul_f32 v[32:33], v[48:49], v[48:49]
  v_pk_mul_f32 v[34:35], v[50:51], v[50:51]
  v_pk_mul_f32 v[36:37], v[52:53], v[52:53]
  v_pk_mul_f32 v[38:39], v[54:55], v[54:55]
  v_pk_mul_f32 v[40:41], v[56:57], v[56:57]
  v_pk_mul_f32 v[42:43], v[58:59], v[58:59]
  v_pk_mul_f32 v[44:45], v[60:61], v[60:61]
  v_pk_mul_f32 v[46:47], v[62:63], v[62:63]
  v_pk_fma_f32 v[32:33], v[32:33], s[70:71], v[18:19] op_sel_hi:[1,0,0]
  v_pk_fma_f32 v[34:35], v[34:35], s[70:71], v[18:19] op_sel_hi:[1,0,0]
  v_pk_fma_f32 v[36:37], v[36:37], s[70:71], v[18:19] op_sel_hi:[1,0,0]
  v_pk_fma_f32 v[38:39], v[38:39], s[70:71], v[18:19] op_sel_hi:[1,0,0]
  v_pk_fma_f32 v[40:41], v[40:41], s[70:71], v[18:19] op_sel_hi:[1,0,0]
  v_pk_fma_f32 v[42:43], v[42:43], s[70:71], v[18:19] op_sel_hi:[1,0,0]
  v_pk_fma_f32 v[44:45], v[44:45], s[70:71], v[18:19] op_sel_hi:[1,0,0]
  v_pk_fma_f32 v[46:47], v[46:47], s[70:71], v[18:19] op_sel_hi:[1,0,0]
  v_pk_mul_f32 v[32:33], v[32:33], v[48:49]
  v_pk_mul_f32 v[34:35], v[34:35], v[50:51]
  v_pk_mul_f32 v[36:37], v[36:37], v[52:53]
  v_pk_mul_f32 v[38:39], v[38:39], v[54:55]
  v_pk_mul_f32 v[40:41], v[40:41], v[56:57]
  v_pk_mul_f32 v[42:43], v[42:43], v[58:59]
  v_pk_mul_f32 v[44:45], v[44:45], v[60:61]
  v_pk_mul_f32 v[46:47], v[46:47], v[62:63]
  v_exp_f32 v32, v32
  v_exp_f32 v33, v33
  v_exp_f32 v34, v34
  v_exp_f32 v35, v35
  v_exp_f32 v36, v36
  v_exp_f32 v37, v37
  v_exp_f32 v38, v38
  v_exp_f32 v39, v39
  v_exp_f32 v40, v40
  v_exp_f32 v41, v41
  v_exp_f32 v42, v42
  v_exp_f32 v43, v43
  v_exp_f32 v44, v44
  v_exp_f32 v45, v45
  v_exp_f32 v46, v46
  v_exp_f32 v47, v47
  s_waitcnt vmcnt(0)
  s_cmp_eq_u32 s13, 1
  s_cbranch_scc0 PS_56
  s_nop 0
  buffer_store_dword v15, off, s[52:55], s65 offset:512
PB_57:
  v_pk_add_f32 v[32:33], v[32:33], 1.0 op_sel_hi:[1,0]
  v_pk_add_f32 v[34:35], v[34:35], 1.0 op_sel_hi:[1,0]
  v_pk_add_f32 v[36:37], v[36:37], 1.0 op_sel_hi:[1,0]
  v_pk_add_f32 v[38:39], v[38:39], 1.0 op_sel_hi:[1,0]
  v_pk_add_f32 v[40:41], v[40:41], 1.0 op_sel_hi:[1,0]
  v_pk_add_f32 v[42:43], v[42:43], 1.0 op_sel_hi:[1,0]
  v_pk_add_f32 v[44:45], v[44:45], 1.0 op_sel_hi:[1,0]
  v_pk_add_f32 v[46:47], v[46:47], 1.0 op_sel_hi:[1,0]
  v_rcp_f32 v32, v32
  v_rcp_f32 v33, v33
  v_rcp_f32 v34, v34
  v_rcp_f32 v35, v35
  v_rcp_f32 v36, v36
  v_rcp_f32 v37, v37
  v_rcp_f32 v38, v38
  v_rcp_f32 v39, v39
  v_rcp_f32 v40, v40
  v_rcp_f32 v41, v41
  v_rcp_f32 v42, v42
  v_rcp_f32 v43, v43
  v_rcp_f32 v44, v44
  v_rcp_f32 v45, v45
  v_rcp_f32 v46, v46
  v_rcp_f32 v47, v47
  v_pk_mul_f32 v[48:49], v[32:33], v[48:49]
  v_pk_mul_f32 v[50:51], v[34:35], v[50:51]
  v_pk_mul_f32 v[52:53], v[36:37], v[52:53]
  v_pk_mul_f32 v[54:55], v[38:39], v[54:55]
  v_pk_mul_f32 v[56:57], v[40:41], v[56:57]
  v_pk_mul_f32 v[58:59], v[42:43], v[58:59]
  v_pk_mul_f32 v[60:61], v[44:45], v[60:61]
  v_pk_mul_f32 v[62:63], v[46:47], v[62:63]
  v_cvt_pk_bf16_f32 v32, v48, v49
  v_cvt_pk_bf16_f32 v33, v50, v51
  v_cvt_pk_bf16_f32 v34, v52, v53
  v_cvt_pk_bf16_f32 v35, v54, v55
  v_cvt_pk_bf16_f32 v36, v56, v57
  v_cvt_pk_bf16_f32 v37, v58, v59
  v_cvt_pk_bf16_f32 v38, v60, v61
  v_cvt_pk_bf16_f32 v39, v62, v63
  buffer_store_dwordx4 v[32:35], v1, s[52:55], s14 offen offset:0 sc1
  buffer_store_dwordx4 v[36:39], v1, s[52:55], s14 offen offset:1024 sc1
  s_add_u32 s14, s14, 0x8000
  ds_read_b128 v[48:51], v21 offset:256
  ds_read_b128 v[52:55], v21 offset:288
  ds_read_b128 v[56:59], v21 offset:320
  ds_read_b128 v[60:63], v21 offset:352
  v_mfma_f32_32x32x16_bf16 v[64:79], v[92:95], v[140:143], v[64:79]
  ds_read_b64_tr_b16 v[88:89], v8 offset:28672
  ds_read_b64_tr_b16 v[90:91], v8 offset:29184
  s_waitcnt lgkmcnt(10)
  v_mfma_f32_32x32x16_bf16 v[64:79], v[96:99], v[144:147], v[64:79]
  ds_read_b64_tr_b16 v[92:93], v8 offset:29696
  ds_read_b64_tr_b16 v[94:95], v8 offset:30208
  s_add_u32 s60, s11, 65536
  s_lshl1_add_u32 s61, s5, s12
  s_cmp_ge_u32 s67, 11
  s_cselect_b32 s72, 0x80000000, 0
  v_add_u32 v20, s72, v1
  s_mul_i32 s72, s12, 3072
  s_add_u32 s50, s11, s72
  s_add_u32 s50, s50, 65536
  s_lshl_b32 s74, s12, 10
  v_mfma_f32_32x32x16_bf16 v[64:79], v[100:103], v[148:151], v[64:79]
  ds_read_b64_tr_b16 v[96:97], v8 offset:30720
  ds_read_b64_tr_b16 v[98:99], v8 offset:31232
  s_waitcnt lgkmcnt(10)
  v_mfma_f32_32x32x16_bf16 v[64:79], v[80:83], v[152:155], v[64:79]
  ds_read_b64_tr_b16 v[100:101], v8 offset:31744
  ds_read_b64_tr_b16 v[102:103], v8 offset:32256
  v_mov_b32 v22, 16
  ds_write_b32 v3, v22 offset:16
  v_mfma_f32_32x32x16_bf16 v[64:79], v[84:87], v[156:159], v[64:79]
  s_waitcnt lgkmcnt(5)
  v_mfma_f32_32x32x16_bf16 v[64:79], v[88:91], v[104:107], v[64:79]
  v_mfma_f32_32x32x16_bf16 v[64:79], v[92:95], v[108:111], v[64:79]
  s_waitcnt lgkmcnt(1)
  v_mfma_f32_32x32x16_bf16 v[64:79], v[96:99], v[112:115], v[64:79]
  v_mfma_f32_32x32x16_bf16 v[64:79], v[100:103], v[116:119], v[64:79]
  buffer_load_dword v23, v17, s[52:55], s15 offen offset:512 sc1
  v_xor_b32 v8, 64, v6
  v_xor_b32 v9, 64, v7
  s_nop 8
  s_nop 0
  v_pk_fma_f32 v[64:65], v[48:49], v[14:15], v[64:65] op_sel_hi:[1,0,1]
  v_pk_fma_f32 v[66:67], v[50:51], v[14:15], v[66:67] op_sel_hi:[1,0,1]
  v_pk_fma_f32 v[68:69], v[52:53], v[14:15], v[68:69] op_sel_hi:[1,0,1]
  v_pk_fma_f32 v[70:71], v[54:55], v[14:15], v[70:71] op_sel_hi:[1,0,1]
  v_pk_fma_f32 v[72:73], v[56:57], v[14:15], v[72:73] op_sel_hi:[1,0,1]
  v_pk_fma_f32 v[74:75], v[58:59], v[14:15], v[74:75] op_sel_hi:[1,0,1]
  v_pk_fma_f32 v[76:77], v[60:61], v[14:15], v[76:77] op_sel_hi:[1,0,1]
  v_pk_fma_f32 v[78:79], v[62:63], v[14:15], v[78:79] op_sel_hi:[1,0,1]
  v_pk_mul_f32 v[64:65], v[64:65], v[16:17] op_sel_hi:[1,0]
  v_pk_mul_f32 v[66:67], v[66:67], v[16:17] op_sel_hi:[1,0]
  v_pk_mul_f32 v[68:69], v[68:69], v[16:17] op_sel_hi:[1,0]
  v_pk_mul_f32 v[70:71], v[70:71], v[16:17] op_sel_hi:[1,0]
  v_pk_mul_f32 v[72:73], v[72:73], v[16:17] op_sel_hi:[1,0]
  v_pk_mul_f32 v[74:75], v[74:75], v[16:17] op_sel_hi:[1,0]
  v_pk_mul_f32 v[76:77], v[76:77], v[16:17] op_sel_hi:[1,0]
  v_pk_mul_f32 v[78:79], v[78:79], v[16:17] op_sel_hi:[1,0]
  v_pk_mul_f32 v[48:49], v[64:65], v[64:65]
  v_pk_mul_f32 v[50:51], v[66:67], v[66:67]
  v_pk_mul_f32 v[52:53], v[68:69], v[68:69]
  v_pk_mul_f32 v[54:55], v[70:71], v[70:71]
  v_pk_mul_f32 v[56:57], v[72:73], v[72:73]
  v_pk_mul_f32 v[58:59], v[74:75], v[74:75]
  v_pk_mul_f32 v[60:61], v[76:77], v[76:77]
  v_pk_mul_f32 v[62:63], v[78:79], v[78:79]
  v_pk_fma_f32 v[48:49], v[48:49], s[70:71], v[18:19] op_sel_hi:[1,0,0]
  v_pk_fma_f32 v[50:51], v[50:51], s[70:71], v[18:19] op_sel_hi:[1,0,0]
  v_pk_fma_f32 v[52:53], v[52:53], s[70:71], v[18:19] op_sel_hi:[1,0,0]
  v_pk_fma_f32 v[54:55], v[54:55], s[70:71], v[18:19] op_sel_hi:[1,0,0]
  v_pk_fma_f32 v[56:57], v[56:57], s[70:71], v[18:19] op_sel_hi:[1,0,0]
  v_pk_fma_f32 v[58:59], v[58:59], s[70:71], v[18:19] op_sel_hi:[1,0,0]
  v_pk_fma_f32 v[60:61], v[60:61], s[70:71], v[18:19] op_sel_hi:[1,0,0]
  v_pk_fma_f32 v[62:63], v[62:63], s[70:71], v[18:19] op_sel_hi:[1,0,0]
  v_pk_mul_f32 v[48:49], v[48:49], v[64:65]
  v_pk_mul_f32 v[50:51], v[50:51], v[66:67]
  v_pk_mul_f32 v[52:53], v[52:53], v[68:69]
  v_pk_mul_f32 v[54:55], v[54:55], v[70:71]
  v_pk_mul_f32 v[56:57], v[56:57], v[72:73]
  v_pk_mul_f32 v[58:59], v[58:59], v[74:75]
  v_pk_mul_f32 v[60:61], v[60:61], v[76:77]
  v_pk_mul_f32 v[62:63], v[62:63], v[78:79]
  v_exp_f32 v48, v48
  v_exp_f32 v49, v49
  v_exp_f32 v50, v50
  v_exp_f32 v51, v51
  v_exp_f32 v52, v52
  v_exp_f32 v53, v53
  v_exp_f32 v54, v54
  v_exp_f32 v55, v55
  v_exp_f32 v56, v56
  v_exp_f32 v57, v57
  v_exp_f32 v58, v58
  v_exp_f32 v59, v59
  v_exp_f32 v60, v60
  v_exp_f32 v61, v61
  v_exp_f32 v62, v62
  v_exp_f32 v63, v63
  s_waitcnt vmcnt(0)
  v_cmp_ne_u32 vcc, v15, v23
  s_cbranch_vccnz SL_58
SD_59:
  s_cmp_eq_u32 s13, 1
  s_cbranch_scc0 PS_61
  s_nop 0
  buffer_store_dword v15, off, s[52:55], s65 offset:768
PB_62:
  buffer_load_dwordx4 v[104:107], v1, s[52:55], s50 offen offset:0 sc1
  v_pk_add_f32 v[48:49], v[48:49], 1.0 op_sel_hi:[1,0]
  v_pk_add_f32 v[50:51], v[50:51], 1.0 op_sel_hi:[1,0]
  v_pk_add_f32 v[52:53], v[52:53], 1.0 op_sel_hi:[1,0]
  v_pk_add_f32 v[54:55], v[54:55], 1.0 op_sel_hi:[1,0]
  v_pk_add_f32 v[56:57], v[56:57], 1.0 op_sel_hi:[1,0]
  v_pk_add_f32 v[58:59], v[58:59], 1.0 op_sel_hi:[1,0]
  buffer_load_dwordx4 v[108:111], v1, s[52:55], s50 offen offset:1024 sc1
  v_pk_add_f32 v[60:61], v[60:61], 1.0 op_sel_hi:[1,0]
  v_pk_add_f32 v[62:63], v[62:63], 1.0 op_sel_hi:[1,0]
  v_rcp_f32 v48, v48
  v_rcp_f32 v49, v49
  v_rcp_f32 v50, v50
  v_rcp_f32 v51, v51
  buffer_load_dwordx4 v[112:115], v1, s[52:55], s50 offen offset:2048 sc1
  v_rcp_f32 v52, v52
  v_rcp_f32 v53, v53
  v_rcp_f32 v54, v54
  v_rcp_f32 v55, v55
  v_rcp_f32 v56, v56
  v_rcp_f32 v57, v57
  s_add_u32 s50, s50, s74
  s_add_u32 s50, s50, 6144
  buffer_load_dwordx4 v[116:119], v1, s[52:55], s50 offen offset:0 sc1
  v_rcp_f32 v58, v58
  v_rcp_f32 v59, v59
  v_rcp_f32 v60, v60
  v_rcp_f32 v61, v61
  v_rcp_f32 v62, v62
  v_rcp_f32_e64 v63, v63
  buffer_load_dwordx4 v[120:123], v1, s[52:55], s50 offen offset:1024 sc1
  v_pk_mul_f32 v[64:65], v[48:49], v[64:65]
  v_pk_mul_f32 v[66:67], v[50:51], v[66:67]
  v_pk_mul_f32 v[68:69], v[52:53], v[68:69]
  v_pk_mul_f32 v[70:71], v[54:55], v[70:71]
  v_pk_mul_f32 v[72:73], v[56:57], v[72:73]
  v_pk_mul_f32 v[74:75], v[58:59], v[74:75]
  buffer_load_dwordx4 v[124:127], v1, s[52:55], s50 offen offset:2048 sc1
  v_pk_mul_f32 v[76:77], v[60:61], v[76:77]
  v_pk_mul_f32 v[78:79], v[62:63], v[78:79]
  v_cvt_pk_bf16_f32 v48, v64, v65
  v_cvt_pk_bf16_f32 v49, v66, v67
  v_cvt_pk_bf16_f32 v50, v68, v69
  v_cvt_pk_bf16_f32 v51, v70, v71
  buffer_load_dwordx4 v[128:131], v1, s[52:55], s50 offen offset:3072 sc1
  v_cvt_pk_bf16_f32 v52, v72, v73
  v_cvt_pk_bf16_f32 v53, v74, v75
  v_cvt_pk_bf16_f32 v54, v76, v77
  v_cvt_pk_bf16_f32 v55, v78, v79
  buffer_store_dwordx4 v[48:51], v20, s[52:55], s14 offen offset:0 sc1
  buffer_store_dwordx4 v[52:55], v20, s[52:55], s14 offen offset:1024 sc1
  v_mov_b32 v22, 0
  ds_write_b32 v3, v22 offset:144
  v_lshlrev_b32 v32, 16, v24
  v_and_b32 v33, 0xffff0000, v24
  v_lshlrev_b32 v34, 16, v25
  v_and_b32 v35, 0xffff0000, v25
  v_lshlrev_b32 v36, 16, v26
  v_and_b32 v37, 0xffff0000, v26
  v_lshlrev_b32 v38, 16, v27
  v_and_b32 v39, 0xffff0000, v27
  v_lshlrev_b32 v40, 16, v28
  v_and_b32 v41, 0xffff0000, v28
  v_lshlrev_b32 v42, 16, v29
  v_and_b32 v43, 0xffff0000, v29
  v_lshlrev_b32 v44, 16, v30
  v_and_b32 v45, 0xffff0000, v30
  v_lshlrev_b32 v46, 16, v31
  v_and_b32 v47, 0xffff0000, v31
  ds_read_b128 v[10:13], v2
  s_waitcnt lgkmcnt(0)
  v_min3_u32 v10, v10, v11, v12
  v_min_u32 v10, v10, v13
  s_nop 0
  v_readfirstlane_b32 s66, v10
  s_cmp_lt_u32 s66, 17
  s_cbranch_scc1 SL_63
SD_64:
  s_nop 0
  ds_read_b64_tr_b16 v[80:81], v8 offset:34816
  ds_read_b64_tr_b16 v[82:83], v8 offset:35840
  ds_read_b64_tr_b16 v[84:85], v6 offset:34816
  ds_read_b64_tr_b16 v[86:87], v6 offset:35840
  ds_read_b64_tr_b16 v[88:89], v8 offset:36864
  ds_read_b64_tr_b16 v[90:91], v8 offset:37888
  ds_read_b64_tr_b16 v[92:93], v6 offset:36864
  ds_read_b64_tr_b16 v[94:95], v6 offset:37888
  ds_read_b64_tr_b16 v[96:97], v8 offset:38912
  ds_read_b64_tr_b16 v[98:99], v8 offset:39936
  s_add_u32 s50, s50, 8192
  buffer_load_dwordx4 v[132:135], v1, s[52:55], s50 offen offset:0 sc1
  buffer_load_dwordx4 v[136:139], v1, s[52:55], s50 offen offset:1024 sc1
  buffer_load_dwordx4 v[140:143], v1, s[52:55], s50 offen offset:2048 sc1
  buffer_load_dwordx4 v[144:147], v1, s[52:55], s50 offen offset:3072 sc1
  s_add_u32 s50, s50, 8192
  buffer_load_dwordx4 v[148:151], v1, s[52:55], s50 offen offset:0 sc1
  buffer_load_dwordx4 v[152:155], v1, s[52:55], s50 offen offset:1024 sc1
  s_waitcnt vmcnt(14)
  s_waitcnt lgkmcnt(6)
  v_mfma_f32_32x32x16_bf16 v[48:63], v[80:83], v[104:107], 0
  ds_read_b64_tr_b16 v[100:101], v6 offset:38912
  ds_read_b64_tr_b16 v[102:103], v6 offset:39936
  v_mfma_f32_32x32x16_bf16 v[32:47], v[84:87], v[104:107], v[32:47]
  s_cmp_lt_u32 s66, 18
  s_cbranch_scc1 SL_66
SD_67:
  ds_read_b64_tr_b16 v[80:81], v8 offset:49152
  ds_read_b64_tr_b16 v[82:83], v8 offset:50176
  buffer_load_dwordx4 v[156:159], v1, s[52:55], s50 offen offset:2048 sc1
  s_mov_b64 exec, 1
  ds_add_u32 v2, v4 offset:108
  s_mov_b64 exec, -1
  s_waitcnt vmcnt(14)
  s_waitcnt lgkmcnt(7)
  v_mfma_f32_32x32x16_bf16 v[48:63], v[88:91], v[108:111], v[48:63]
  ds_read_b64_tr_b16 v[84:85], v6 offset:49152
  ds_read_b64_tr_b16 v[86:87], v6 offset:50176
  v_mov_b32_e64 v22, 17
  ds_write_b32 v3, v22 offset:16
  buffer_load_dword v23, v17, s[52:55], s15 offen offset:768 sc1
  v_mfma_f32_32x32x16_bf16 v[32:47], v[92:95], v[108:111], v[32:47]
  ds_read_b64_tr_b16 v[88:89], v8 offset:51200
  ds_read_b64_tr_b16 v[90:91], v8 offset:52224
  buffer_load_dwordx4 v[104:107], v1, s[52:55], s50 offen offset:3072 sc1
  s_waitcnt vmcnt(15)
  s_waitcnt lgkmcnt(8)
  v_mfma_f32_32x32x16_bf16 v[48:63], v[96:99], v[112:115], v[48:63]
  ds_read_b64_tr_b16 v[92:93], v6 offset:51200
  ds_read_b64_tr_b16 v[94:95], v6 offset:52224
  v_mfma_f32_32x32x16_bf16 v[32:47], v[100:103], v[112:115], v[32:47]
  ds_read_b64_tr_b16 v[96:97], v8 offset:53248
  ds_read_b64_tr_b16 v[98:99], v8 offset:54272
  s_waitcnt vmcnt(14)
  s_waitcnt lgkmcnt(7)
  v_mfma_f32_32x32x16_bf16 v[48:63], v[80:83], v[116:119], v[48:63]
  ds_read_b64_tr_b16 v[100:101], v6 offset:53248
  ds_read_b64_tr_b16 v[102:103], v6 offset:54272
  v_mfma_f32_32x32x16_bf16 v[32:47], v[84:87], v[116:119], v[32:47]
  ds_read_b64_tr_b16 v[80:81], v8 offset:55296
  ds_read_b64_tr_b16 v[82:83], v8 offset:56320
  s_waitcnt vmcnt(13)
  s_waitcnt lgkmcnt(6)
  v_mfma_f32_32x32x16_bf16 v[48:63], v[88:91], v[120:123], v[48:63]
  ds_read_b64_tr_b16 v[84:85], v6 offset:55296
  ds_read_b64_tr_b16 v[86:87], v6 offset:56320
  v_mfma_f32_32x32x16_bf16 v[32:47], v[92:95], v[120:123], v[32:47]
  s_cmp_lt_u32 s66, 19
  s_cbranch_scc1 SL_69
SD_70:
  ds_read_b64_tr_b16 v[88:89], v9 offset:0
  ds_read_b64_tr_b16 v[90:91], v9 offset:1024
  s_waitcnt vmcnt(12)
  s_waitcnt lgkmcnt(6)
  v_mfma_f32_32x32x16_bf16 v[48:63], v[96:99], v[124:127], v[48:63]
  ds_read_b64_tr_b16 v[92:93], v7 offset:0
  ds_read_b64_tr_b16 v[94:95], v7 offset:1024
  v_mov_b32 v22, 18
  ds_write_b32 v3, v22 offset:16
  v_mfma_f32_32x32x16_bf16 v[32:47], v[100:103], v[124:127], v[32:47]
  ds_read_b64_tr_b16 v[96:97], v9 offset:2048
  ds_read_b64_tr_b16 v[98:99], v9 offset:3072
  s_waitcnt vmcnt(11)
  s_waitcnt lgkmcnt(7)
  v_mfma_f32_32x32x16_bf16 v[48:63], v[80:83], v[128:131], v[48:63]
  ds_read_b64_tr_b16 v[100:101], v7 offset:2048
  ds_read_b64_tr_b16 v[102:103], v7 offset:3072
  v_mfma_f32_32x32x16_bf16 v[32:47], v[84:87], v[128:131], v[32:47]
  ds_read_b64_tr_b16 v[80:81], v9 offset:4096
  ds_read_b64_tr_b16 v[82:83], v9 offset:5120
  s_waitcnt vmcnt(8)
  s_waitcnt lgkmcnt(7)
  v_mfma_f32_32x32x16_bf16 v[48:63], v[88:91], v[132:135], v[48:63]
  ds_read_b64_tr_b16 v[84:85], v7 offset:4096
  ds_read_b64_tr_b16 v[86:87], v7 offset:5120
  s_waitcnt vmcnt(1)
  v_cmp_ne_u32 vcc, v15, v23
  s_cbranch_vccnz SL_72
SD_73:
  s_add_u32 s50, s50, 8192
  buffer_load_dwordx4 v[108:111], v1, s[52:55], s50 offen offset:0 sc1
  s_cmp_eq_u32 s13, 1
  s_cbranch_scc0 PS_75
  buffer_store_dword v15, off, s[52:55], s65 offset:1024
PB_76:
  v_mfma_f32_32x32x16_bf16 v[32:47], v[92:95], v[132:135], v[32:47]
  ds_read_b64_tr_b16 v[88:89], v9 offset:6144
  ds_read_b64_tr_b16 v[90:91], v9 offset:7168
  buffer_load_dwordx4 v[112:115], v1, s[52:55], s50 offen offset:1024 sc1
  s_waitcnt lgkmcnt(6)
  v_mfma_f32_32x32x16_bf16 v[48:63], v[96:99], v[136:139], v[48:63]
  ds_read_b64_tr_b16 v[92:93], v7 offset:6144
  ds_read_b64_tr_b16 v[94:95], v7 offset:7168
  buffer_load_dwordx4 v[116:119], v1, s[52:55], s50 offen offset:2048 sc1
  v_mfma_f32_32x32x16_bf16 v[32:47], v[100:103], v[136:139], v[32:47]
  s_cmp_lt_u32 s66, 20
  s_cbranch_scc1 SL_77
SD_78:
  ds_read_b64_tr_b16 v[96:97], v9 offset:16384
  ds_read_b64_tr_b16 v[98:99], v9 offset:17408
  buffer_load_dwordx4 v[120:123], v1, s[52:55], s50 offen offset:3072 sc1
  s_waitcnt lgkmcnt(6)
  v_mfma_f32_32x32x16_bf16 v[48:63], v[80:83], v[140:143], v[48:63]
  ds_read_b64_tr_b16 v[100:101], v7 offset:16384
  ds_read_b64_tr_b16 v[102:103], v7 offset:17408
  v_mov_b32_e64 v22, 19
  ds_write_b32 v3, v22 offset:16
  s_add_u32 s50, s50, 8192
  buffer_load_dwordx4 v[124:127], v1, s[52:55], s50 offen offset:0 sc1
  v_mfma_f32_32x32x16_bf16 v[32:47], v[84:87], v[140:143], v[32:47]
  ds_read_b64_tr_b16 v[80:81], v9 offset:18432
  ds_read_b64_tr_b16 v[82:83], v9 offset:19456
  ds_read_b128 v[10:13], v2
  buffer_load_dwordx4 v[128:131], v1, s[52:55], s50 offen offset:1024 sc1
  s_waitcnt lgkmcnt(8)
  v_mfma_f32_32x32x16_bf16 v[48:63], v[88:91], v[144:147], v[48:63]
  ds_read_b64_tr_b16 v[84:85], v7 offset:18432
  ds_read_b64_tr_b16 v[86:87], v7 offset:19456
  buffer_load_dwordx4 v[132:135], v1, s[52:55], s50 offen offset:2048 sc1
  v_mfma_f32_32x32x16_bf16 v[32:47], v[92:95], v[144:147], v[32:47]
  ds_read_b64_tr_b16 v[88:89], v9 offset:20480
  ds_read_b64_tr_b16 v[90:91], v9 offset:21504
  buffer_load_dwordx4 v[136:139], v1, s[52:55], s50 offen offset:3072 sc1
  s_waitcnt lgkmcnt(8)
  v_mfma_f32_32x32x16_bf16 v[48:63], v[96:99], v[148:151], v[48:63]
  ds_read_b64_tr_b16 v[92:93], v7 offset:20480
  ds_read_b64_tr_b16 v[94:95], v7 offset:21504
  s_add_u32 s50, s50, 8192
  buffer_load_dwordx4 v[140:143], v1, s[52:55], s50 offen offset:0 sc1
  v_mfma_f32_32x32x16_bf16 v[32:47], v[100:103], v[148:151], v[32:47]
  ds_read_b64_tr_b16 v[96:97], v9 offset:22528
  ds_read_b64_tr_b16 v[98:99], v9 offset:23552
  s_waitcnt lgkmcnt(8)
  v_min3_u32 v10, v10, v11, v12
  v_min_u32 v10, v10, v13
  s_nop 0
  v_readfirstlane_b32 s66, v10
  buffer_load_dwordx4 v[144:147], v1, s[52:55], s50 offen offset:1024 sc1
  s_waitcnt lgkmcnt(6)
  v_mfma_f32_32x32x16_bf16 v[48:63], v[80:83], v[152:155], v[48:63]
  ds_read_b64_tr_b16 v[100:101], v7 offset:22528
  ds_read_b64_tr_b16 v[102:103], v7 offset:23552
  v_mfma_f32_32x32x16_bf16 v[32:47], v[84:87], v[152:155], v[32:47]
  s_cmp_lt_u32 s66, 21
  s_cbranch_scc1 SL_80
SD_81:
  ds_read_b64_tr_b16 v[80:81], v9 offset:32768
  ds_read_b64_tr_b16 v[82:83], v9 offset:33792
  buffer_load_dwordx4 v[148:151], v1, s[52:55], s50 offen offset:2048 sc1
  s_waitcnt lgkmcnt(6)
  v_mfma_f32_32x32x16_bf16 v[48:63], v[88:91], v[156:159], v[48:63]
  ds_read_b64_tr_b16 v[84:85], v7 offset:32768
  ds_read_b64_tr_b16 v[86:87], v7 offset:33792
  v_mov_b32_e64 v22, 20
  ds_write_b32 v3, v22 offset:16
  v_mfma_f32_32x32x16_bf16 v[32:47], v[92:95], v[156:159], v[32:47]
  ds_read_b64_tr_b16 v[88:89], v9 offset:34816
  ds_read_b64_tr_b16 v[90:91], v9 offset:35840
  ds_read_b128 v[10:13], v2
  buffer_load_dwordx4 v[152:155], v1, s[52:55], s50 offen offset:3072 sc1
  s_waitcnt vmcnt(13)
  s_waitcnt lgkmcnt(8)
  v_mfma_f32_32x32x16_bf16 v[48:63], v[96:99], v[104:107], v[48:63]
  ds_read_b64_tr_b16 v[92:93], v7 offset:34816
  ds_read_b64_tr_b16 v[94:95], v7 offset:35840
  v_mfma_f32_32x32x16_bf16 v[32:47], v[100:103], v[104:107], v[32:47]
  ds_read_b64_tr_b16 v[96:97], v9 offset:36864
  ds_read_b64_tr_b16 v[98:99], v9 offset:37888
  s_add_u32 s50, s50, 8192
  buffer_load_dwordx4 v[156:159], v1, s[52:55], s50 offen offset:0 sc1
  s_waitcnt vmcnt(13)
  s_waitcnt lgkmcnt(8)
  v_mfma_f32_32x32x16_bf16 v[48:63], v[80:83], v[108:111], v[48:63]
  ds_read_b64_tr_b16 v[100:101], v7 offset:36864
  ds_read_b64_tr_b16 v[102:103], v7 offset:37888
  buffer_load_dword v23, v17, s[52:55], s15 offen offset:1024 sc1
  v_mfma_f32_32x32x16_bf16 v[32:47], v[84:87], v[108:111], v[32:47]
  ds_read_b64_tr_b16 v[80:81], v9 offset:38912
  ds_read_b64_tr_b16 v[82:83], v9 offset:39936
  s_waitcnt lgkmcnt(8)
  v_min3_u32 v10, v10, v11, v12
  v_min_u32 v10, v10, v13
  s_nop 0
  v_readfirstlane_b32 s66, v10
  buffer_load_dwordx4 v[104:107], v1, s[52:55], s50 offen offset:1024 sc1
  s_waitcnt vmcnt(13)
  s_waitcnt lgkmcnt(6)
  v_mfma_f32_32x32x16_bf16 v[48:63], v[88:91], v[112:115], v[48:63]
  ds_read_b64_tr_b16 v[84:85], v7 offset:38912
  ds_read_b64_tr_b16 v[86:87], v7 offset:39936
  v_mfma_f32_32x32x16_bf16 v[32:47], v[92:95], v[112:115], v[32:47]
  s_cmp_lt_u32 s66, 22
  s_cbranch_scc1 SL_83
SD_84:
  ds_read_b64_tr_b16 v[88:89], v8 offset:0
  ds_read_b64_tr_b16 v[90:91], v8 offset:1024
  buffer_load_dwordx4 v[108:111], v1, s[52:55], s50 offen offset:2048 sc1
  s_waitcnt vmcnt(13)
  s_waitcnt lgkmcnt(6)
  v_mfma_f32_32x32x16_bf16 v[48:63], v[96:99], v[116:119], v[48:63]
  ds_read_b64_tr_b16 v[92:93], v6 offset:0
  ds_read_b64_tr_b16 v[94:95], v6 offset:1024
  v_mov_b32_e64 v22, 21
  ds_write_b32 v3, v22 offset:16
  v_mfma_f32_32x32x16_bf16 v[32:47], v[100:103], v[116:119], v[32:47]
  ds_read_b64_tr_b16 v[96:97], v8 offset:2048
  ds_read_b64_tr_b16 v[98:99], v8 offset:3072
  ds_read_b128 v[10:13], v2
  buffer_load_dwordx4 v[112:115], v1, s[52:55], s50 offen offset:3072 sc1
  s_waitcnt vmcnt(13)
  s_waitcnt lgkmcnt(8)
  v_mfma_f32_32x32x16_bf16 v[48:63], v[80:83], v[120:123], v[48:63]
  ds_read_b64_tr_b16 v[100:101], v6 offset:2048
  ds_read_b64_tr_b16 v[102:103], v6 offset:3072
  v_mfma_f32_32x32x16_bf16 v[32:47], v[84:87], v[120:123], v[32:47]
  ds_read_b64_tr_b16 v[80:81], v8 offset:4096
  ds_read_b64_tr_b16 v[82:83], v8 offset:5120
  s_waitcnt vmcnt(12)
  s_waitcnt lgkmcnt(8)
  v_mfma_f32_32x32x16_bf16 v[48:63], v[88:91], v[124:127], v[48:63]
  ds_read_b64_tr_b16 v[84:85], v6 offset:4096
  ds_read_b64_tr_b16 v[86:87], v6 offset:5120
  v_mfma_f32_32x32x16_bf16 v[32:47], v[92:95], v[124:127], v[32:47]
  ds_read_b64_tr_b16 v[88:89], v8 offset:6144
  ds_read_b64_tr_b16 v[90:91], v8 offset:7168
  s_waitcnt lgkmcnt(8)
  v_min3_u32 v10, v10, v11, v12
  v_min_u32 v10, v10, v13
  s_nop 0
  v_readfirstlane_b32 s66, v10
  s_waitcnt vmcnt(11)
  s_waitcnt lgkmcnt(6)
  v_mfma_f32_32x32x16_bf16 v[48:63], v[96:99], v[128:131], v[48:63]
  ds_read_b64_tr_b16 v[92:93], v6 offset:6144
  ds_read_b64_tr_b16 v[94:95], v6 offset:7168
  s_mov_b64 exec, 1
  ds_add_u32 v2, v4 offset:108
  s_mov_b64 exec, -1
  v_mfma_f32_32x32x16_bf16 v[32:47], v[100:103], v[128:131], v[32:47]
  s_cmp_lt_u32 s66, 23
  s_cbranch_scc1 SL_86
SD_87:
  ds_read_b64_tr_b16 v[96:97], v8 offset:16384
  ds_read_b64_tr_b16 v[98:99], v8 offset:17408
  s_waitcnt vmcnt(10)
  s_waitcnt lgkmcnt(7)
  v_mfma_f32_32x32x16_bf16 v[48:63], v[80:83], v[132:135], v[48:63]
  ds_read_b64_tr_b16 v[100:101], v6 offset:16384
  ds_read_b64_tr_b16 v[102:103], v6 offset:17408
  v_mfma_f32_32x32x16_bf16 v[32:47], v[84:87], v[132:135], v[32:47]
  ds_read_b64_tr_b16 v[80:81], v8 offset:18432
  ds_read_b64_tr_b16 v[82:83], v8 offset:19456
  ds_read_b128 v[10:13], v2
  s_waitcnt vmcnt(9)
  s_waitcnt lgkmcnt(8)
  v_mfma_f32_32x32x16_bf16 v[48:63], v[88:91], v[136:139], v[48:63]
  ds_read_b64_tr_b16 v[84:85], v6 offset:18432
  ds_read_b64_tr_b16 v[86:87], v6 offset:19456
  s_waitcnt vmcnt(3)
  v_cmp_ne_u32 vcc, v15, v23
  s_cbranch_vccnz SL_89
SD_90:
  s_add_u32 s50, s50, 8192
  buffer_load_dwordx4 v[116:119], v1, s[52:55], s50 offen offset:0 sc1
  s_lshl_b32 s75, s3, 11
  s_add_u32 s75, s75, 114688
  v_lshrrev_b32 v64, 5, v0
  v_mfma_f32_32x32x16_bf16 v[32:47], v[92:95], v[136:139], v[32:47]
  ds_read_b64_tr_b16 v[88:89], v8 offset:20480
  ds_read_b64_tr_b16 v[90:91], v8 offset:21504
  buffer_load_dwordx4 v[120:123], v1, s[52:55], s50 offen offset:1024 sc1
  s_waitcnt lgkmcnt(7)
  v_mfma_f32_32x32x16_bf16 v[48:63], v[96:99], v[140:143], v[48:63]
  ds_read_b64_tr_b16 v[92:93], v6 offset:20480
  ds_read_b64_tr_b16 v[94:95], v6 offset:21504
  buffer_load_dwordx4 v[124:127], v1, s[52:55], s50 offen offset:2048 sc1
  v_bfe_u32 v65, v0, 2, 2
  v_lshl_add_u32 v66, v64, 2, v65
  v_lshlrev_b32 v66, 6, v66
  v_mfma_f32_32x32x16_bf16 v[32:47], v[100:103], v[140:143], v[32:47]
  ds_read_b64_tr_b16 v[96:97], v8 offset:22528
  ds_read_b64_tr_b16 v[98:99], v8 offset:23552
  s_waitcnt lgkmcnt(8)
  v_min3_u32 v10, v10, v11, v12
  v_min_u32 v10, v10, v13
  s_nop 0
  v_readfirstlane_b32 s66, v10
  buffer_load_dwordx4 v[128:131], v1, s[52:55], s50 offen offset:3072 sc1
  s_waitcnt lgkmcnt(6)
  v_mfma_f32_32x32x16_bf16 v[48:63], v[80:83], v[144:147], v[48:63]
  ds_read_b64_tr_b16 v[100:101], v6 offset:22528
  ds_read_b64_tr_b16 v[102:103], v6 offset:23552
  s_add_u32 s50, s50, 8192
  buffer_load_dwordx4 v[132:135], v1, s[52:55], s50 offen offset:0 sc1
  v_bfe_u32 v64, v0, 4, 1
  v_lshl_add_u32 v66, v64, 5, v66
  v_and_b32 v64, 3, v0
  v_mfma_f32_32x32x16_bf16 v[32:47], v[84:87], v[144:147], v[32:47]
  s_cmp_lt_u32 s66, 24
  s_cbranch_scc1 SL_92
SD_93:
  ds_read_b64_tr_b16 v[80:81], v8 offset:32768
  ds_read_b64_tr_b16 v[82:83], v8 offset:33792
  buffer_load_dwordx4 v[136:139], v1, s[52:55], s50 offen offset:1024 sc1
  s_waitcnt lgkmcnt(6)
  v_mfma_f32_32x32x16_bf16 v[48:63], v[88:91], v[148:151], v[48:63]
  ds_read_b64_tr_b16 v[84:85], v6 offset:32768
  ds_read_b64_tr_b16 v[86:87], v6 offset:33792
  buffer_load_dwordx4 v[140:143], v1, s[52:55], s50 offen offset:2048 sc1
  v_lshl_add_u32 v66, v64, 3, v66
  v_add_u32 v66, s75, v66
  v_and_b32 v64, 31, v0
  v_mfma_f32_32x32x16_bf16 v[32:47], v[92:95], v[148:151], v[32:47]
  ds_read_b64_tr_b16 v[88:89], v8 offset:34816
  ds_read_b64_tr_b16 v[90:91], v8 offset:35840
  ds_read_b128 v[10:13], v2
  buffer_load_dwordx4 v[144:147], v1, s[52:55], s50 offen offset:3072 sc1
  s_waitcnt lgkmcnt(7)
  v_mfma_f32_32x32x16_bf16 v[48:63], v[96:99], v[152:155], v[48:63]
  ds_read_b64_tr_b16 v[92:93], v6 offset:34816
  ds_read_b64_tr_b16 v[94:95], v6 offset:35840
  v_lshrrev_b32 v65, 5, v0
  v_bfe_u32 v67, v0, 1, 2
  v_lshlrev_b32_e64 v67, 4, v67
  v_mfma_f32_32x32x16_bf16 v[32:47], v[100:103], v[152:155], v[32:47]
  ds_read_b64_tr_b16 v[96:97], v8 offset:36864
  ds_read_b64_tr_b16 v[98:99], v8 offset:37888
  s_add_u32 s50, s50, 8192
  buffer_load_dwordx4 v[148:151], v1, s[52:55], s50 offen offset:0 sc1
  s_waitcnt lgkmcnt(7)
  s_nop 0
  v_mfma_f32_32x32x16_bf16 v[48:63], v[80:83], v[156:159], v[48:63]
  ds_read_b64_tr_b16 v[100:101], v6 offset:36864
  ds_read_b64_tr_b16 v[102:103], v6 offset:37888
  v_lshl_add_u32 v67, v64, 6, v67
  v_lshl_add_u32 v67, v65, 3, v67
  v_add_u32 v68, s75, v67
  v_mfma_f32_32x32x16_bf16 v[32:47], v[84:87], v[156:159], v[32:47]
  ds_read_b64_tr_b16 v[80:81], v8 offset:38912
  ds_read_b64_tr_b16 v[82:83], v8 offset:39936
  s_waitcnt lgkmcnt(8)
  v_min3_u32 v10, v10, v11, v12
  v_min_u32 v10, v10, v13
  s_nop 0
  v_readfirstlane_b32 s66, v10
  buffer_load_dwordx4 v[152:155], v1, s[52:55], s50 offen offset:1024 sc1
  s_waitcnt vmcnt(12)
  s_waitcnt lgkmcnt(6)
  v_mfma_f32_32x32x16_bf16 v[48:63], v[88:91], v[104:107], v[48:63]
  ds_read_b64_tr_b16 v[84:85], v6 offset:38912
  ds_read_b64_tr_b16 v[86:87], v6 offset:39936
  v_xor_b32 v69, 16, v68
  v_xor_b32 v70, 32, v68
  v_xor_b32 v71, 48, v68
  v_mfma_f32_32x32x16_bf16 v[32:47], v[92:95], v[104:107], v[32:47]
  s_cmp_lt_u32 s66, 25
  s_cbranch_scc1 SL_95
SD_96:
  ds_read_b64_tr_b16 v[88:89], v8 offset:49152
  ds_read_b64_tr_b16 v[90:91], v8 offset:50176
  buffer_load_dwordx4 v[156:159], v1, s[52:55], s50 offen offset:2048 sc1
  s_waitcnt vmcnt(12)
  s_waitcnt lgkmcnt(6)
  v_mfma_f32_32x32x16_bf16 v[48:63], v[96:99], v[108:111], v[48:63]
  ds_read_b64_tr_b16 v[92:93], v6 offset:49152
  ds_read_b64_tr_b16 v[94:95], v6 offset:50176
  v_lshrrev_b32 v64, 2, v0
  v_and_b32 v65, 3, v0
  v_bfe_u32 v67, v0, 3, 2
  v_mfma_f32_32x32x16_bf16 v[32:47], v[100:103], v[108:111], v[32:47]
  ds_read_b64_tr_b16 v[96:97], v8 offset:51200
  ds_read_b64_tr_b16 v[98:99], v8 offset:52224
  ds_read_b128 v[10:13], v2
  buffer_load_dwordx4 v[104:107], v1, s[52:55], s50 offen offset:3072 sc1
  s_waitcnt vmcnt(12)
  s_waitcnt lgkmcnt(7)
  v_mfma_f32_32x32x16_bf16 v[48:63], v[80:83], v[112:115], v[48:63]
  ds_read_b64_tr_b16 v[100:101], v6 offset:51200
  ds_read_b64_tr_b16 v[102:103], v6 offset:52224
  v_xor_b32 v67, v67, v65
  v_lshlrev_b32 v67, 4, v67
  v_lshl_add_u32 v67, v64, 6, v67
  v_mfma_f32_32x32x16_bf16 v[32:47], v[84:87], v[112:115], v[32:47]
  ds_read_b64_tr_b16 v[80:81], v8 offset:53248
  ds_read_b64_tr_b16 v[82:83], v8 offset:54272
  s_waitcnt vmcnt(11)
  s_waitcnt lgkmcnt(7)
  v_mfma_f32_32x32x16_bf16 v[48:63], v[88:91], v[116:119], v[48:63]
  ds_read_b64_tr_b16 v[84:85], v6 offset:53248
  ds_read_b64_tr_b16 v[86:87], v6 offset:54272
  v_add_u32 v72, s75, v67
  v_lshlrev_b32 v64, 10, v64
  v_lshl_add_u32 v73, v65, 4, v64
  v_mfma_f32_32x32x16_bf16 v[32:47], v[92:95], v[116:119], v[32:47]
  ds_read_b64_tr_b16 v[88:89], v8 offset:55296
  ds_read_b64_tr_b16 v[90:91], v8 offset:56320
  s_waitcnt lgkmcnt(8)
  v_min3_u32 v10, v10, v11, v12
  v_min_u32 v10, v10, v13
  s_nop 0
  v_readfirstlane_b32 s66, v10
  s_waitcnt vmcnt(10)
  s_waitcnt lgkmcnt(6)
  v_mfma_f32_32x32x16_bf16 v[48:63], v[96:99], v[120:123], v[48:63]
  ds_read_b64_tr_b16 v[92:93], v6 offset:55296
  ds_read_b64_tr_b16 v[94:95], v6 offset:56320
  s_lshl1_add_u32 s72, s4, s10
  s_lshl_b32 s72, s72, 15
  s_lshl1_add_u32 s73, s5, s12
  v_mfma_f32_32x32x16_bf16 v[32:47], v[100:103], v[120:123], v[32:47]
  s_cmp_lt_u32 s66, 26
  s_cbranch_scc1 SL_98
SD_99:
  ds_read_b64_tr_b16 v[96:97], v9 offset:0
  ds_read_b64_tr_b16 v[98:99], v9 offset:1024
  ds_read_b128 v[10:13], v2
  s_waitcnt vmcnt(9)
  s_waitcnt lgkmcnt(7)
  v_mfma_f32_32x32x16_bf16 v[48:63], v[80:83], v[124:127], v[48:63]
  ds_read_b64_tr_b16 v[100:101], v7 offset:0
  ds_read_b64_tr_b16 v[102:103], v7 offset:1024
  s_lshl_b32 s73, s73, 6
  s_add_u32 s72, s72, s73
  s_add_u32 s73, s72, 0x4000
  v_mfma_f32_32x32x16_bf16 v[32:47], v[84:87], v[124:127], v[32:47]
  ds_read_b64_tr_b16 v[80:81], v9 offset:2048
  ds_read_b64_tr_b16 v[82:83], v9 offset:3072
  s_waitcnt vmcnt(8)
  s_waitcnt lgkmcnt(7)
  v_mfma_f32_32x32x16_bf16 v[48:63], v[88:91], v[128:131], v[48:63]
  ds_read_b64_tr_b16 v[84:85], v7 offset:2048
  ds_read_b64_tr_b16 v[86:87], v7 offset:3072
  s_mov_b32 s70, 0xbfb8aa3b
  s_mov_b32 s56, s44
  s_mov_b32 s57, s45
  v_mfma_f32_32x32x16_bf16 v[32:47], v[92:95], v[128:131], v[32:47]
  ds_read_b64_tr_b16 v[88:89], v9 offset:4096
  ds_read_b64_tr_b16 v[90:91], v9 offset:5120
  s_waitcnt lgkmcnt(8)
  v_min3_u32 v10, v10, v11, v12
  v_min_u32 v10, v10, v13
  s_nop 0
  v_readfirstlane_b32 s66, v10
  s_waitcnt vmcnt(7)
  s_waitcnt lgkmcnt(6)
  v_mfma_f32_32x32x16_bf16 v[48:63], v[96:99], v[132:135], v[48:63]
  ds_read_b64_tr_b16 v[92:93], v9 offset:6144
  ds_read_b64_tr_b16 v[94:95], v9 offset:7168
  s_mov_b32 s58, 0x00200000
  s_mov_b32 s59, 0x20000
  v_mfma_f32_32x32x16_bf16 v[32:47], v[100:103], v[132:135], v[32:47]
  s_cmp_lt_u32 s66, 27
  s_cbranch_scc1 SL_101
SD_102:
  ds_read_b64_tr_b16 v[96:97], v9 offset:16384
  ds_read_b64_tr_b16 v[98:99], v9 offset:17408
  s_waitcnt vmcnt(6)
  s_waitcnt lgkmcnt(6)
  v_mfma_f32_32x32x16_bf16 v[48:63], v[80:83], v[136:139], v[48:63]
  ds_read_b64_tr_b16 v[100:101], v9 offset:18432
  ds_read_b64_tr_b16 v[102:103], v9 offset:19456
  v_mfma_f32_32x32x16_bf16 v[32:47], v[84:87], v[136:139], v[32:47]
  ds_read_b64_tr_b16 v[80:81], v9 offset:20480
  ds_read_b64_tr_b16 v[82:83], v9 offset:21504
  s_waitcnt vmcnt(4)
  s_waitcnt lgkmcnt(6)
  v_mfma_f32_32x32x16_bf16 v[48:63], v[88:91], v[140:143], v[48:63]
  ds_read_b64_tr_b16 v[84:85], v9 offset:22528
  ds_read_b64_tr_b16 v[86:87], v9 offset:23552
  v_mfma_f32_32x32x16_bf16 v[48:63], v[92:95], v[144:147], v[48:63]
  ds_read_b64_tr_b16 v[88:89], v7 offset:4096
  ds_read_b64_tr_b16 v[90:91], v7 offset:5120
  ds_read_b128 v[10:13], v2
  s_waitcnt vmcnt(2)
  s_waitcnt lgkmcnt(7)
  v_mfma_f32_32x32x16_bf16 v[48:63], v[96:99], v[148:151], v[48:63]
  ds_read_b64_tr_b16 v[92:93], v7 offset:6144
  ds_read_b64_tr_b16 v[94:95], v7 offset:7168
  v_mfma_f32_32x32x16_bf16 v[48:63], v[100:103], v[152:155], v[48:63]
  ds_read_b64_tr_b16 v[96:97], v7 offset:16384
  ds_read_b64_tr_b16 v[98:99], v7 offset:17408
  s_waitcnt vmcnt(0)
  s_waitcnt lgkmcnt(7)
  v_mfma_f32_32x32x16_bf16 v[48:63], v[80:83], v[156:159], v[48:63]
  ds_read_b64_tr_b16 v[100:101], v7 offset:18432
  ds_read_b64_tr_b16 v[102:103], v7 offset:19456
  s_waitcnt lgkmcnt(6)
  v_min3_u32 v10, v10, v11, v12
  v_min_u32 v10, v10, v13
  s_nop 0
  v_readfirstlane_b32 s66, v10
  v_mfma_f32_32x32x16_bf16 v[48:63], v[84:87], v[104:107], v[48:63]
  ds_read_b64_tr_b16 v[80:81], v7 offset:20480
  ds_read_b64_tr_b16 v[82:83], v7 offset:21504
  s_waitcnt lgkmcnt(6)
  v_mfma_f32_32x32x16_bf16 v[32:47], v[88:91], v[140:143], v[32:47]
  ds_read_b64_tr_b16 v[84:85], v7 offset:22528
  ds_read_b64_tr_b16 v[86:87], v7 offset:23552
  v_add_u32 v23, 98304, v19
  s_cmp_lt_u32 s66, 28
  s_cbranch_scc1 SL_104
SD_105:
  v_mfma_f32_32x32x16_bf16 v[32:47], v[92:95], v[144:147], v[32:47]
  s_nop 1
  ds_write_b128 v23, v[48:51] offset:0
  ds_write_b128 v23, v[52:55] offset:1024
  s_waitcnt lgkmcnt(6)
  v_mfma_f32_32x32x16_bf16 v[32:47], v[96:99], v[148:151], v[32:47]
  ds_write_b128 v23, v[56:59] offset:2048
  ds_write_b128 v23, v[60:63] offset:3072
  v_mov_b32 v22, 3
  ds_write_b32 v3, v22 offset:64
  v_mfma_f32_32x32x16_bf16 v[32:47], v[100:103], v[152:155], v[32:47]
  s_waitcnt lgkmcnt(5)
  v_mfma_f32_32x32x16_bf16 v[32:47], v[80:83], v[156:159], v[32:47]
  v_mfma_f32_32x32x16_bf16 v[32:47], v[84:87], v[104:107], v[32:47]
  v_xor_b32 v23, 0x1000, v23
  v_xor_b32_e64 v96, 4, v3
  ds_read_b32 v97, v96 offset:64
  ds_read_b128 v[80:83], v23 offset:0
  ds_read_b128 v[84:87], v23 offset:1024
  ds_read_b128 v[88:91], v23 offset:2048
  ds_read_b128 v[92:95], v23 offset:3072
  ds_read_b32 v156, v3 offset:48
  ds_read_b64_tr_b16 v[24:25], v66 offset:0
  ds_read_b64_tr_b16 v[26:27], v66 offset:512
  ds_read_b64_tr_b16 v[28:29], v66 offset:1024
  ds_read_b64_tr_b16 v[30:31], v66 offset:1536
  v_lshlrev_b32 v140, 16, v160
  v_and_b32 v141, 0xffff0000, v160
  v_lshlrev_b32 v142, 16, v161
  v_and_b32 v143, 0xffff0000, v161
  v_lshlrev_b32 v144, 16, v162
  v_and_b32 v145, 0xffff0000, v162
  v_lshlrev_b32 v146, 16, v163
  v_and_b32 v147, 0xffff0000, v163
  v_lshlrev_b32 v148, 16, v164
  v_and_b32 v149, 0xffff0000, v164
  v_lshlrev_b32 v150, 16, v165
  v_and_b32 v151, 0xffff0000, v165
  v_lshlrev_b32 v152, 16, v166
  v_and_b32 v153, 0xffff0000, v166
  v_lshlrev_b32 v154, 16, v167
  v_and_b32 v155, 0xffff0000, v167
  s_waitcnt lgkmcnt(0)
  v_mul_u32_u24 v97, v97, v156
  v_cmp_gt_u32 vcc, 3, v97
  s_cbranch_vccz SD_108
SL_107:
  s_sub_u32 s68, s68, 1
  s_cbranch_scc1 ST_109
  ds_read_b32 v97, v96 offset:64
  ds_read_b128 v[80:83], v23 offset:0
  ds_read_b128 v[84:87], v23 offset:1024
  ds_read_b128 v[88:91], v23 offset:2048
  ds_read_b128 v[92:95], v23 offset:3072
  ds_read_b32 v156, v3 offset:48
  ds_read_b64_tr_b16 v[24:25], v66 offset:0
  ds_read_b64_tr_b16 v[26:27], v66 offset:512
  ds_read_b64_tr_b16 v[28:29], v66 offset:1024
  ds_read_b64_tr_b16 v[30:31], v66 offset:1536
  s_waitcnt lgkmcnt(0)
  v_mul_u32_u24 v97, v97, v156
  v_cmp_gt_u32 vcc, 3, v97
  s_cbranch_vccnz SL_107
SD_108:
  v_pk_add_f32 v[32:33], v[32:33], v[80:81]
  v_pk_add_f32 v[34:35], v[34:35], v[82:83]
  v_pk_add_f32 v[36:37], v[36:37], v[84:85]
  v_pk_add_f32 v[38:39], v[38:39], v[86:87]
  v_pk_add_f32 v[40:41], v[40:41], v[88:89]
  v_pk_add_f32 v[42:43], v[42:43], v[90:91]
  v_pk_add_f32 v[44:45], v[44:45], v[92:93]
  v_pk_add_f32 v[46:47], v[46:47], v[94:95]
  v_lshlrev_b32 v124, 16, v24
  v_and_b32 v125, 0xffff0000, v24
  v_lshlrev_b32 v126, 16, v25
  v_and_b32 v127, 0xffff0000, v25
  v_lshlrev_b32 v128, 16, v26
  v_and_b32 v129, 0xffff0000, v26
  v_lshlrev_b32 v130, 16, v27
  v_and_b32 v131, 0xffff0000, v27
  v_lshlrev_b32 v132, 16, v28
  v_and_b32 v133, 0xffff0000, v28
  v_lshlrev_b32 v134, 16, v29
  v_and_b32 v135, 0xffff0000, v29
  v_lshlrev_b32 v136, 16, v30
  v_and_b32 v137, 0xffff0000, v30
  v_lshlrev_b32 v138, 16, v31
  v_and_b32 v139, 0xffff0000, v31
  v_pk_mul_f32 v[104:105], v[32:33], s[70:71] op_sel_hi:[1,0]
  v_pk_mul_f32 v[106:107], v[34:35], s[70:71] op_sel_hi:[1,0]
  v_pk_mul_f32 v[108:109], v[36:37], s[70:71] op_sel_hi:[1,0]
  v_pk_mul_f32 v[110:111], v[38:39], s[70:71] op_sel_hi:[1,0]
  v_pk_mul_f32 v[112:113], v[40:41], s[70:71] op_sel_hi:[1,0]
  v_pk_mul_f32 v[114:115], v[42:43], s[70:71] op_sel_hi:[1,0]
  v_pk_mul_f32 v[116:117], v[44:45], s[70:71] op_sel_hi:[1,0]
  v_pk_mul_f32 v[118:119], v[46:47], s[70:71] op_sel_hi:[1,0]
  v_exp_f32 v104, v104
  v_exp_f32 v105, v105
  v_exp_f32 v106, v106
  v_exp_f32 v107, v107
  v_exp_f32 v108, v108
  v_exp_f32 v109, v109
  v_exp_f32 v110, v110
  v_exp_f32 v111, v111
  v_exp_f32 v112, v112
  v_exp_f32 v113, v113
  v_exp_f32 v114, v114
  v_exp_f32 v115, v115
  v_exp_f32 v116, v116
  v_exp_f32 v117, v117
  v_exp_f32 v118, v118
  v_exp_f32 v119, v119
  v_pk_mul_f32 v[124:125], v[124:125], v[32:33]
  v_pk_mul_f32 v[126:127], v[126:127], v[34:35]
  v_pk_mul_f32 v[128:129], v[128:129], v[36:37]
  v_pk_mul_f32 v[130:131], v[130:131], v[38:39]
  v_pk_mul_f32 v[132:133], v[132:133], v[40:41]
  v_pk_mul_f32 v[134:135], v[134:135], v[42:43]
  v_pk_mul_f32 v[136:137], v[136:137], v[44:45]
  v_pk_mul_f32 v[138:139], v[138:139], v[46:47]
  v_pk_add_f32 v[104:105], v[104:105], 1.0 op_sel_hi:[1,0]
  v_pk_add_f32 v[106:107], v[106:107], 1.0 op_sel_hi:[1,0]
  v_pk_add_f32 v[108:109], v[108:109], 1.0 op_sel_hi:[1,0]
  v_pk_add_f32 v[110:111], v[110:111], 1.0 op_sel_hi:[1,0]
  v_pk_add_f32 v[112:113], v[112:113], 1.0 op_sel_hi:[1,0]
  v_pk_add_f32 v[114:115], v[114:115], 1.0 op_sel_hi:[1,0]
  v_pk_add_f32 v[116:117], v[116:117], 1.0 op_sel_hi:[1,0]
  v_pk_add_f32 v[118:119], v[118:119], 1.0 op_sel_hi:[1,0]
  v_rcp_f32 v104, v104
  v_rcp_f32 v105, v105
  v_rcp_f32 v106, v106
  v_rcp_f32 v107, v107
  v_rcp_f32 v108, v108
  v_rcp_f32 v109, v109
  v_rcp_f32 v110, v110
  v_rcp_f32 v111, v111
  v_rcp_f32 v112, v112
  v_rcp_f32 v113, v113
  v_rcp_f32 v114, v114
  v_rcp_f32 v115, v115
  v_rcp_f32 v116, v116
  v_rcp_f32 v117, v117
  v_rcp_f32 v118, v118
  v_rcp_f32 v119, v119
  v_pk_fma_f32 v[104:105], v[104:105], v[124:125], v[140:141]
  v_pk_fma_f32 v[106:107], v[106:107], v[126:127], v[142:143]
  v_pk_fma_f32 v[108:109], v[108:109], v[128:129], v[144:145]
  v_pk_fma_f32 v[110:111], v[110:111], v[130:131], v[146:147]
  v_pk_fma_f32 v[112:113], v[112:113], v[132:133], v[148:149]
  v_pk_fma_f32 v[114:115], v[114:115], v[134:135], v[150:151]
  v_pk_fma_f32 v[116:117], v[116:117], v[136:137], v[152:153]
  v_pk_fma_f32 v[118:119], v[118:119], v[138:139], v[154:155]
  v_cvt_pk_bf16_f32 v124, v104, v105
  v_cvt_pk_bf16_f32 v125, v106, v107
  v_cvt_pk_bf16_f32 v126, v108, v109
  v_cvt_pk_bf16_f32 v127, v110, v111
  v_cvt_pk_bf16_f32 v128, v112, v113
  v_cvt_pk_bf16_f32 v129, v114, v115
  v_cvt_pk_bf16_f32 v130, v116, v117
  v_cvt_pk_bf16_f32 v131, v118, v119
  ds_write_b64 v68, v[124:125]
  ds_write_b64 v69, v[126:127]
  ds_write_b64 v70, v[128:129]
  ds_write_b64 v71, v[130:131]
  ds_read_b128 v[104:107], v72
  ds_read_b128 v[108:111], v72 offset:1024
  s_waitcnt lgkmcnt(1)
  buffer_store_dwordx4 v[104:107], v73, s[56:59], s72 offen nt
  s_waitcnt lgkmcnt(0)
  buffer_store_dwordx4 v[108:111], v73, s[56:59], s73 offen nt
L_exit:
  s_endpgm
ST_6:
  s_mov_b32 s68, 0
  s_branch SD_5
PS_7:
  buffer_store_dword v15, off, s[52:55], s51 offset:0 sc1
  s_branch PB_8
SL_9:
  s_sub_u32 s68, s68, 1
  s_cbranch_scc1 ST_11
  ds_read_b128 v[10:13], v2
  s_waitcnt lgkmcnt(0)
  v_min3_u32 v10, v10, v11, v12
  v_min_u32 v10, v10, v13
  s_nop 0
  v_readfirstlane_b32 s66, v10
  s_cmp_lt_u32 s66, 6
  s_cbranch_scc1 SL_9
  s_branch SD_10
ST_11:
  s_mov_b32 s68, 0
  s_branch SD_10
SL_15:
  s_sub_u32 s68, s68, 1
  s_cbranch_scc1 ST_17
  ds_read_b128 v[10:13], v2
  s_waitcnt lgkmcnt(0)
  v_min3_u32 v10, v10, v11, v12
  v_min_u32 v10, v10, v13
  s_nop 0
  v_readfirstlane_b32 s66, v10
  s_cmp_lt_u32 s66, 7
  s_cbranch_scc1 SL_15
  s_branch SD_16
ST_17:
  s_mov_b32 s68, 0
  s_branch SD_16
SL_18:
  s_sub_u32 s68, s68, 1
  s_cbranch_scc1 ST_20
  ds_read_b128 v[10:13], v2
  s_waitcnt lgkmcnt(0)
  v_min3_u32 v10, v10, v11, v12
  v_min_u32 v10, v10, v13
  s_nop 0
  v_readfirstlane_b32 s66, v10
  s_cmp_lt_u32 s66, 8
  s_cbranch_scc1 SL_18
  s_branch SD_19
ST_20:
  s_mov_b32 s68, 0
  s_branch SD_19
SL_21:
  s_sub_u32 s68, s68, 1
  s_cbranch_scc1 ST_23
  ds_read_b128 v[10:13], v2
  s_waitcnt lgkmcnt(0)
  v_min3_u32 v10, v10, v11, v12
  v_min_u32 v10, v10, v13
  s_nop 0
  v_readfirstlane_b32 s66, v10
  s_cmp_lt_u32 s66, 9
  s_cbranch_scc1 SL_21
  s_branch SD_22
ST_23:
  s_mov_b32 s68, 0
  s_branch SD_22
SL_24:
  s_sub_u32 s68, s68, 1
  s_cbranch_scc1 ST_26
  ds_read_b128 v[10:13], v2
  s_waitcnt lgkmcnt(0)
  v_min3_u32 v10, v10, v11, v12
  v_min_u32 v10, v10, v13
  s_nop 0
  v_readfirstlane_b32 s66, v10
  s_cmp_lt_u32 s66, 10
  s_cbranch_scc1 SL_24
  s_branch SD_25
ST_26:
  s_mov_b32 s68, 0
  s_branch SD_25
ST_29:
  s_mov_b32 s68, 0
  s_branch SD_28
PS_30:
  buffer_store_dword v15, off, s[52:55], s51 offset:256 sc1
  s_branch PB_31
SL_32:
  s_sub_u32 s68, s68, 1
  s_cbranch_scc1 ST_34
  ds_read_b128 v[10:13], v2
  s_waitcnt lgkmcnt(0)
  v_min3_u32 v10, v10, v11, v12
  v_min_u32 v10, v10, v13
  s_nop 0
  v_readfirstlane_b32 s66, v10
  s_cmp_lt_u32 s66, 11
  s_cbranch_scc1 SL_32
  s_branch SD_33
ST_34:
  s_mov_b32 s68, 0
  s_branch SD_33
SL_35:
  s_sub_u32 s68, s68, 1
  s_cbranch_scc1 ST_37
  ds_read_b128 v[10:13], v2
  s_waitcnt lgkmcnt(0)
  v_min3_u32 v10, v10, v11, v12
  v_min_u32 v10, v10, v13
  s_nop 0
  v_readfirstlane_b32 s66, v10
  s_cmp_lt_u32 s66, 12
  s_cbranch_scc1 SL_35
  s_branch SD_36
ST_37:
  s_mov_b32 s68, 0
  s_branch SD_36
SL_38:
  s_sub_u32 s68, s68, 1
  s_cbranch_scc1 ST_40
  ds_read_b128 v[10:13], v2
  s_waitcnt lgkmcnt(0)
  v_min3_u32 v10, v10, v11, v12
  v_min_u32 v10, v10, v13
  s_nop 0
  v_readfirstlane_b32 s66, v10
  s_cmp_lt_u32 s66, 13
  s_cbranch_scc1 SL_38
  s_branch SD_39
ST_40:
  s_mov_b32 s68, 0
  s_branch SD_39
SL_44:
  s_sub_u32 s68, s68, 1
  s_cbranch_scc1 ST_46
  ds_read_b128 v[10:13], v2
  s_waitcnt lgkmcnt(0)
  v_min3_u32 v10, v10, v11, v12
  v_min_u32 v10, v10, v13
  s_nop 0
  v_readfirstlane_b32 s66, v10
  s_cmp_lt_u32 s66, 14
  s_cbranch_scc1 SL_44
  s_branch SD_45
ST_46:
  s_mov_b32 s68, 0
  s_branch SD_45
SL_47:
  s_sub_u32 s68, s68, 1
  s_cbranch_scc1 ST_49
  ds_read_b128 v[10:13], v2
  s_waitcnt lgkmcnt(0)
  v_min3_u32 v10, v10, v11, v12
  v_min_u32 v10, v10, v13
  s_nop 0
  v_readfirstlane_b32 s66, v10
  s_cmp_lt_u32 s66, 15
  s_cbranch_scc1 SL_47
  s_branch SD_48
ST_49:
  s_mov_b32 s68, 0
  s_branch SD_48
SL_50:
  s_sub_u32 s68, s68, 1
  s_cbranch_scc1 ST_52
  ds_read_b128 v[10:13], v2
  s_waitcnt lgkmcnt(0)
  v_min3_u32 v10, v10, v11, v12
  v_min_u32 v10, v10, v13
  s_nop 0
  v_readfirstlane_b32 s66, v10
  s_cmp_lt_u32 s66, 16
  s_cbranch_scc1 SL_50
  s_branch SD_51
ST_52:
  s_mov_b32 s68, 0
  s_branch SD_51
SL_53:
  s_sub_u32 s68, s68, 1
  s_cbranch_scc1 ST_55
  ds_read_b32 v10, v2 offset:36
  ds_read_b32 v11, v3 offset:160
  ds_read_b32 v14, v20
  ds_read_b32 v16, v20 offset:512
  ds_read_b128 v[120:123], v21 offset:0
  ds_read_b128 v[124:127], v21 offset:32
  ds_read_b128 v[128:131], v21 offset:64
  ds_read_b128 v[132:135], v21 offset:96
  s_waitcnt lgkmcnt(0)
  v_min_u32 v10, v10, v11
  v_cmp_eq_u32 vcc, 0, v10
  s_cbranch_vccnz SL_53
  s_branch SD_54
ST_55:
  s_mov_b32 s68, 0
  s_branch SD_54
PS_56:
  buffer_store_dword v15, off, s[52:55], s65 offset:512 sc1
  s_branch PB_57
SL_58:
  s_sub_u32 s68, s68, 1
  s_cbranch_scc1 ST_60
  buffer_load_dword v23, v17, s[52:55], s15 offen offset:512 sc1
  s_waitcnt vmcnt(0)
  v_cmp_ne_u32 vcc, v15, v23
  s_cbranch_vccnz SL_58
  s_branch SD_59
ST_60:
  s_mov_b32 s68, 0
  s_branch SD_59
PS_61:
  buffer_store_dword v15, off, s[52:55], s65 offset:768 sc1
  s_branch PB_62
SL_63:
  s_sub_u32 s68, s68, 1
  s_cbranch_scc1 ST_65
  ds_read_b128 v[10:13], v2
  s_waitcnt lgkmcnt(0)
  v_min3_u32 v10, v10, v11, v12
  v_min_u32 v10, v10, v13
  s_nop 0
  v_readfirstlane_b32 s66, v10
  s_cmp_lt_u32 s66, 17
  s_cbranch_scc1 SL_63
  s_branch SD_64
ST_65:
  s_mov_b32 s68, 0
  s_branch SD_64
SL_66:
  s_sub_u32 s68, s68, 1
  s_cbranch_scc1 ST_68
  ds_read_b128 v[10:13], v2
  s_waitcnt lgkmcnt(0)
  v_min3_u32 v10, v10, v11, v12
  v_min_u32 v10, v10, v13
  s_nop 0
  v_readfirstlane_b32 s66, v10
  s_cmp_lt_u32 s66, 18
  s_cbranch_scc1 SL_66
  s_branch SD_67
ST_68:
  s_mov_b32 s68, 0
  s_branch SD_67
SL_69:
  s_sub_u32 s68, s68, 1
  s_cbranch_scc1 ST_71
  ds_read_b128 v[10:13], v2
  s_waitcnt lgkmcnt(0)
  v_min3_u32 v10, v10, v11, v12
  v_min_u32 v10, v10, v13
  s_nop 0
  v_readfirstlane_b32 s66, v10
  s_cmp_lt_u32 s66, 19
  s_cbranch_scc1 SL_69
  s_branch SD_70
ST_71:
  s_mov_b32 s68, 0
  s_branch SD_70
SL_72:
  s_sub_u32 s68, s68, 1
  s_cbranch_scc1 ST_74
  buffer_load_dword v23, v17, s[52:55], s15 offen offset:768 sc1
  s_waitcnt vmcnt(0)
  v_cmp_ne_u32 vcc, v15, v23
  s_cbranch_vccnz SL_72
  s_branch SD_73
ST_74:
  s_mov_b32 s68, 0
  s_branch SD_73
PS_75:
  buffer_store_dword v15, off, s[52:55], s65 offset:1024 sc1
  s_branch PB_76
SL_77:
  s_sub_u32 s68, s68, 1
  s_cbranch_scc1 ST_79
  ds_read_b128 v[10:13], v2
  s_waitcnt lgkmcnt(0)
  v_min3_u32 v10, v10, v11, v12
  v_min_u32 v10, v10, v13
  s_nop 0
  v_readfirstlane_b32 s66, v10
  s_cmp_lt_u32 s66, 20
  s_cbranch_scc1 SL_77
  s_branch SD_78
ST_79:
  s_mov_b32 s68, 0
  s_branch SD_78
SL_80:
  s_sub_u32 s68, s68, 1
  s_cbranch_scc1 ST_82
  ds_read_b128 v[10:13], v2
  s_waitcnt lgkmcnt(0)
  v_min3_u32 v10, v10, v11, v12
  v_min_u32 v10, v10, v13
  s_nop 0
  v_readfirstlane_b32 s66, v10
  s_cmp_lt_u32 s66, 21
  s_cbranch_scc1 SL_80
  s_branch SD_81
ST_82:
  s_mov_b32 s68, 0
  s_branch SD_81
SL_83:
  s_sub_u32 s68, s68, 1
  s_cbranch_scc1 ST_85
  ds_read_b128 v[10:13], v2
  s_waitcnt lgkmcnt(0)
  v_min3_u32 v10, v10, v11, v12
  v_min_u32 v10, v10, v13
  s_nop 0
  v_readfirstlane_b32 s66, v10
  s_cmp_lt_u32 s66, 22
  s_cbranch_scc1 SL_83
  s_branch SD_84
ST_85:
  s_mov_b32 s68, 0
  s_branch SD_84
SL_86:
  s_sub_u32 s68, s68, 1
  s_cbranch_scc1 ST_88
  ds_read_b128 v[10:13], v2
  s_waitcnt lgkmcnt(0)
  v_min3_u32 v10, v10, v11, v12
  v_min_u32 v10, v10, v13
  s_nop 0
  v_readfirstlane_b32 s66, v10
  s_cmp_lt_u32 s66, 23
  s_cbranch_scc1 SL_86
  s_branch SD_87
ST_88:
  s_mov_b32 s68, 0
  s_branch SD_87
SL_89:
  s_sub_u32 s68, s68, 1
  s_cbranch_scc1 ST_91
  buffer_load_dword v23, v17, s[52:55], s15 offen offset:1024 sc1
  s_waitcnt vmcnt(0)
  v_cmp_ne_u32 vcc, v15, v23
  s_cbranch_vccnz SL_89
  s_branch SD_90
ST_91:
  s_mov_b32 s68, 0
  s_branch SD_90
SL_92:
  s_sub_u32 s68, s68, 1
  s_cbranch_scc1 ST_94
  ds_read_b128 v[10:13], v2
  s_waitcnt lgkmcnt(0)
  v_min3_u32 v10, v10, v11, v12
  v_min_u32 v10, v10, v13
  s_nop 0
  v_readfirstlane_b32 s66, v10
  s_cmp_lt_u32 s66, 24
  s_cbranch_scc1 SL_92
  s_branch SD_93
ST_94:
  s_mov_b32 s68, 0
  s_branch SD_93
SL_95:
  s_sub_u32 s68, s68, 1
  s_cbranch_scc1 ST_97
  ds_read_b128 v[10:13], v2
  s_waitcnt lgkmcnt(0)
  v_min3_u32 v10, v10, v11, v12
  v_min_u32 v10, v10, v13
  s_nop 0
  v_readfirstlane_b32 s66, v10
  s_cmp_lt_u32 s66, 25
  s_cbranch_scc1 SL_95
  s_branch SD_96
ST_97:
  s_mov_b32 s68, 0
  s_branch SD_96
SL_98:
  s_sub_u32 s68, s68, 1
  s_cbranch_scc1 ST_100
  ds_read_b128 v[10:13], v2
  s_waitcnt lgkmcnt(0)
  v_min3_u32 v10, v10, v11, v12
  v_min_u32 v10, v10, v13
  s_nop 0
  v_readfirstlane_b32 s66, v10
  s_cmp_lt_u32 s66, 26
  s_cbranch_scc1 SL_98
  s_branch SD_99
ST_100:
  s_mov_b32 s68, 0
  s_branch SD_99
SL_101:
  s_sub_u32 s68, s68, 1
  s_cbranch_scc1 ST_103
  ds_read_b128 v[10:13], v2
  s_waitcnt lgkmcnt(0)
  v_min3_u32 v10, v10, v11, v12
  v_min_u32 v10, v10, v13
  s_nop 0
  v_readfirstlane_b32 s66, v10
  s_cmp_lt_u32 s66, 27
  s_cbranch_scc1 SL_101
  s_branch SD_102
ST_103:
  s_mov_b32 s68, 0
  s_branch SD_102
SL_104:
  s_sub_u32 s68, s68, 1
  s_cbranch_scc1 ST_106
  ds_read_b128 v[10:13], v2
  s_waitcnt lgkmcnt(0)
  v_min3_u32 v10, v10, v11, v12
  v_min_u32 v10, v10, v13
  s_nop 0
  v_readfirstlane_b32 s66, v10
  s_cmp_lt_u32 s66, 28
  s_cbranch_scc1 SL_104
  s_branch SD_105
ST_106:
  s_mov_b32 s68, 0
  s_branch SD_105
ST_109:
  s_mov_b32 s68, 0
  s_branch SD_108
L_roleL:
  s_mov_b32 s72, 19931136
  s_load_dword s7, s[48:49], s72
  s_and_b32 s67, s4, 1
  s_lshl3_add_u32 s67, s67, s5
  s_mul_i32 s69, s4, 324608
  s_mov_b32 s68, 2097152
  s_mov_b32 s52, s48
  s_mov_b32 s53, s49
  s_mov_b32 s54, 0x01a00000
  s_mov_b32 s55, 0x20000
  v_lshrrev_b32 v6, 3, v0
  v_and_b32 v7, 7, v0
  v_lshrrev_b32 v10, 2, v0
  v_and_b32 v10, 4, v10
  v_xor_b32 v7, v7, v10
  v_lshlrev_b32 v7, 4, v7
  v_lshl_add_u32 v1, v6, 10, v7
  s_mov_b32 s60, s38
  s_mov_b32 s61, s39
  s_mov_b32 s62, 0x00080000
  s_mov_b32 s63, 0x20000
  s_mov_b32 s24, s40
  s_mov_b32 s25, s41
  s_mov_b32 s26, 0x00158000
  s_mov_b32 s27, 0x20000
  s_mov_b32 s28, s42
  s_mov_b32 s29, s43
  s_mov_b32 s30, 0x00158000
  s_mov_b32 s31, 0x20000
  s_lshl_b32 s11, s67, 6
  s_mov_b32 s10, 0
  s_lshl_b32 s72, s15, 15
  s_lshl_b32 s73, s5, 7
  s_add_u32 s72, s72, s73
  s_add_u32 s74, s15, 1
  s_lshr_b32 s74, s74, 1
  s_add_u32 s74, s74, 1
  s_lshr_b32 s75, s15, 1
  s_add_u32 s75, s75, 1
  s_lshl_b32 s75, s75, 14
  s_sub_u32 s75, s72, s75
  v_add_u32 v2, s75, v1
  v_add_u32 v1, s72, v1
  v_lshrrev_b32 v6, 2, v0
  v_mul_u32_u24 v3, 2752, v6
  v_and_b32 v6, 3, v0
  v_lshl_add_u32 v3, v6, 4, v3
  s_mul_i32 s72, s15, 176128
  s_add_u32 s72, s72, s11
  v_add_u32 v3, s72, v3
  s_lshl2_add_u32 s72, s15, 157184
  v_mov_b32 v5, s72
  s_lshl_b32 s72, s15, 12
  v_lshl_add_u32 v12, v0, 4, s72
  v_add_u32 v13, 0x10000, v12
  v_lshrrev_b32 v6, 5, v0
  v_bfe_u32 v7, v0, 2, 2
  v_lshl_add_u32 v14, v6, 2, v7
  v_lshlrev_b32 v14, 7, v14
  v_and_b32 v6, 2, v7
  v_bfe_u32 v7, v0, 4, 1
  v_xor_b32 v6, v6, v7
  v_lshl_add_u32 v14, v6, 5, v14
  v_and_b32 v6, 3, v0
  v_lshl_add_u32 v14, v6, 3, v14
  v_add_u32 v14, s72, v14
  v_xor_b32 v15, 64, v14
  v_lshrrev_b32 v6, 5, v0
  v_bfe_u32 v7, v0, 2, 2
  v_lshl_add_u32 v16, v6, 2, v7
  v_lshlrev_b32 v16, 6, v16
  v_bfe_u32 v7, v0, 4, 1
  v_lshl_add_u32 v16, v7, 5, v16
  v_and_b32 v6, 3, v0
  v_lshl_add_u32 v16, v6, 3, v16
  v_add_u32 v16, s72, v16
  v_add_u32 v17, 0x10000, v16
  v_and_b32 v6, 15, v0
  v_mov_b32 v8, 0x3f803f80
  v_cmp_eq_u32 vcc, v6, v7
  s_cmp_ge_u32 s67, 11
  s_cselect_b32 s12, 0x80000000, 0
  v_cndmask_b32 v18, 0, v8, vcc
  v_cndmask_b32 v19, 0, v8, vcc
  v_cndmask_b32 v20, 0, v8, vcc
  v_cndmask_b32 v21, 0, v8, vcc
  s_getreg_b32 s51, hwreg(HW_REG_XCC_ID, 0, 4)
  s_and_b32 s51, s51, 7
  s_and_b32 s50, s4, 30
  s_mul_i32 s50, s50, 324608
  s_add_u32 s50, s50, 319488
  s_waitcnt lgkmcnt(0)
  s_add_u32 s7, s7, 0x9e3779b9
  s_xor_b32 s51, s7, s51
  s_cmp_eq_u32 s15, 3
  s_cbranch_scc0 L_nox
  v_mov_b32 v7, s7
  ds_write_b32 v4, v7 offset:100
  v_mov_b32 v6, s51
  s_lshl2_add_u32 s72, s67, s50
  buffer_store_dword v6, off, s[52:55], s72 sc1
L_nox:
  v_and_b32 v31, 15, v0
  v_lshrrev_b32 v32, 4, v0
  v_mov_b32 v33, 1
  v_mul_u32_u24 v22, 1040, v31
  v_lshl_add_u32 v22, v32, 4, v22
  s_lshl4_add_u32 s72, s15, s9
  s_mul_i32 s73, s72, 1040
  s_add_u32 s73, s73, 65536
  v_add_u32 v22, s73, v22
  s_sub_u32 s72, s72, s9
  s_lshl2_add_u32 s72, s72, 160528
  v_lshl_add_u32 v23, v31, 2, s72
  v_lshrrev_b32 v24, 3, v31
  v_mul_u32_u24 v26, 16, v24
  v_lshl_add_u32 v26, v31, 7, v26
  v_lshl_add_u32 v26, v32, 4, v26
  s_cmp_eq_u32 s9, 0
  s_cselect_b32 s72, 66560, 0
  s_cselect_b32 s73, 0x108, 0
  s_add_u32 s72, s72, 65536
  v_add_u32 v26, s72, v26
  s_add_u32 s72, s73, 160520
  v_lshl_add_u32 v24, v24, 2, s72
  v_cmp_eq_u32 vcc, 1, v32
  s_nop 1
  v_cndmask_b32 v23, v23, v24, vcc
  v_mov_b32 v116, 0x3f803f80
  v_mov_b32 v117, 0x3f803f80
  v_mov_b32 v118, 0x3f803f80
  v_mov_b32 v119, 0x3f803f80
  v_lshlrev_b32 v27, 2, v32
  v_sub_u32 v27, v31, v27
  v_lshrrev_b32 v29, 2, v31
  v_mul_u32_u24 v28, 1040, v29
  v_and_b32 v30, 3, v0
  v_lshl_add_u32 v28, v30, 3, v28
  v_lshl_add_u32 v28, v32, 5, v28
  s_lshl4_add_u32 s72, s15, s9
  s_mul_i32 s72, s72, 1040
  s_lshl_b32 s73, s5, 7
  s_add_u32 s72, s72, s73
  s_add_u32 s72, s72, 65536
  v_add_u32 v28, s72, v28
  v_lshrrev_b32 v29, 2, v0
  v_mul_u32_u24 v29, 24576, v29
  v_lshl_add_u32 v30, v30, 4, v29
  s_mul_i32 s72, s5, 393216
  s_lshl2_add_u32 s73, s4, s15
  s_lshl_b32 s73, s73, 6
  s_add_u32 s72, s72, s73
  s_add_u32 s16, s72, 16777216
  s_add_u32 s17, s16, 8192
  s_add_u32 s18, s16, 16384
  s_lshl2_add_u32 s72, s5, s15
  s_mul_i32 s72, s72, 384
  s_add_u32 s72, s72, s69
  s_add_u32 s72, s72, 307200
  v_min_u32 v6, 2, v0
  v_lshlrev_b32 v6, 7, v6
  buffer_load_dword v39, v6, s[52:55], s72 offen sc1
  s_lshl2_add_u32 s72, s2, s15
  s_mul_i32 s72, s72, 512
  v_min_u32 v6, 3, v0
  v_lshl_add_u32 v6, v6, 7, s72
  buffer_load_dword v39, v6, s[60:63], 0 offen
  s_lshl2_add_u32 s72, s2, s15
  s_mul_i32 s72, s72, 1408
  v_min_u32 v6, 10, v0
  v_lshl_add_u32 v6, v6, 7, s72
  buffer_load_dword v39, v6, s[24:27], 0 offen
  s_lshl2_add_u32 s72, s2, s15
  s_mul_i32 s72, s72, 1408
  v_min_u32 v6, 10, v0
  v_lshl_add_u32 v6, v6, 7, s72
  buffer_load_dword v39, v6, s[28:31], 0 offen
  s_waitcnt lgkmcnt(0)
  s_barrier
  s_setprio 3
  ds_read_b128 v[120:123], v22 offset:0
  ds_read_b128 v[124:127], v22 offset:64
  ds_read_b128 v[128:131], v22 offset:128
  ds_read_b128 v[132:135], v22 offset:192
  ds_read_b128 v[136:139], v22 offset:256
  ds_read_b128 v[140:143], v22 offset:320
  ds_read_b128 v[144:147], v26
  ds_read_b128 v[148:151], v26 offset:64
  s_waitcnt lgkmcnt(7)
  v_mfma_f32_16x16x32_bf16 v[104:107], v[116:119], v[120:123], 0
  v_mfma_f32_16x16x32_bf16 v[108:111], v[120:123], v[120:123], 0
  s_waitcnt lgkmcnt(6)
  v_mfma_f32_16x16x32_bf16 v[104:107], v[116:119], v[124:127], v[104:107]
  ds_read_b128 v[120:123], v22 offset:384
  v_mfma_f32_16x16x32_bf16 v[108:111], v[124:127], v[124:127], v[108:111]
  s_waitcnt lgkmcnt(6)
  v_mfma_f32_16x16x32_bf16 v[104:107], v[116:119], v[128:131], v[104:107]
  ds_read_b128 v[124:127], v22 offset:448
  v_mfma_f32_16x16x32_bf16 v[108:111], v[128:131], v[128:131], v[108:111]
  s_waitcnt lgkmcnt(6)
  v_mfma_f32_16x16x32_bf16 v[104:107], v[116:119], v[132:135], v[104:107]
  ds_read_b128 v[128:131], v22 offset:512
  v_mfma_f32_16x16x32_bf16 v[108:111], v[132:135], v[132:135], v[108:111]
  s_waitcnt lgkmcnt(6)
  v_mfma_f32_16x16x32_bf16 v[104:107], v[116:119], v[136:139], v[104:107]
  ds_read_b128 v[132:135], v22 offset:576
  v_mfma_f32_16x16x32_bf16 v[108:111], v[136:139], v[136:139], v[108:111]
  s_waitcnt lgkmcnt(6)
  v_mfma_f32_16x16x32_bf16 v[104:107], v[116:119], v[140:143], v[104:107]
  ds_read_b128 v[136:139], v22 offset:640
  v_mfma_f32_16x16x32_bf16 v[108:111], v[140:143], v[140:143], v[108:111]
  s_waitcnt lgkmcnt(4)
  v_mfma_f32_16x16x32_bf16 v[104:107], v[116:119], v[120:123], v[104:107]
  ds_read_b128 v[140:143], v22 offset:704
  v_mfma_f32_16x16x32_bf16 v[108:111], v[120:123], v[120:123], v[108:111]
  s_waitcnt lgkmcnt(4)
  v_mfma_f32_16x16x32_bf16 v[104:107], v[116:119], v[124:127], v[104:107]
  ds_read_b128 v[120:123], v22 offset:768
  v_mfma_f32_16x16x32_bf16 v[108:111], v[124:127], v[124:127], v[108:111]
  s_waitcnt lgkmcnt(4)
  v_mfma_f32_16x16x32_bf16 v[104:107], v[116:119], v[128:131], v[104:107]
  ds_read_b128 v[124:127], v22 offset:832
  v_mfma_f32_16x16x32_bf16 v[108:111], v[128:131], v[128:131], v[108:111]
  s_waitcnt lgkmcnt(4)
  v_mfma_f32_16x16x32_bf16 v[104:107], v[116:119], v[132:135], v[104:107]
  ds_read_b128 v[128:131], v22 offset:896
  v_mfma_f32_16x16x32_bf16 v[108:111], v[132:135], v[132:135], v[108:111]
  s_waitcnt lgkmcnt(4)
  v_mfma_f32_16x16x32_bf16 v[104:107], v[116:119], v[136:139], v[104:107]
  ds_read_b128 v[132:135], v22 offset:960
  v_mfma_f32_16x16x32_bf16 v[108:111], v[136:139], v[136:139], v[108:111]
  s_waitcnt lgkmcnt(4)
  v_mfma_f32_16x16x32_bf16 v[104:107], v[116:119], v[140:143], v[104:107]
  v_mfma_f32_16x16x32_bf16 v[108:111], v[140:143], v[140:143], v[108:111]
  ds_read_b64_tr_b16 v[152:153], v28 offset:0
  ds_read_b64_tr_b16 v[154:155], v28 offset:4160
  ds_read_b64_tr_b16 v[156:157], v28 offset:8320
  ds_read_b64_tr_b16 v[158:159], v28 offset:12480
  ds_read_b32 v29, v4 offset:100
  s_barrier
  buffer_load_dwordx4 v[40:43], v1, s[60:63], 0 offen
  s_waitcnt lgkmcnt(8)
  v_mfma_f32_16x16x32_bf16 v[104:107], v[116:119], v[120:123], v[104:107]
  v_mfma_f32_16x16x32_bf16 v[108:111], v[120:123], v[120:123], v[108:111]
  s_waitcnt lgkmcnt(7)
  v_mfma_f32_16x16x32_bf16 v[104:107], v[116:119], v[124:127], v[104:107]
  v_mfma_f32_16x16x32_bf16 v[108:111], v[124:127], v[124:127], v[108:111]
  s_waitcnt lgkmcnt(6)
  v_mfma_f32_16x16x32_bf16 v[104:107], v[116:119], v[128:131], v[104:107]
  v_mfma_f32_16x16x32_bf16 v[108:111], v[128:131], v[128:131], v[108:111]
  s_waitcnt lgkmcnt(5)
  s_mov_b32 s72, 8192
  buffer_load_dwordx4 v[44:47], v1, s[60:63], s72 offen
  v_mfma_f32_16x16x32_bf16 v[104:107], v[116:119], v[132:135], v[104:107]
  v_mfma_f32_16x16x32_bf16 v[108:111], v[132:135], v[132:135], v[108:111]
  v_mfma_f32_16x16x32_bf16 v[136:139], v[116:119], v[144:147], 0
  v_mfma_f32_16x16x32_bf16 v[140:143], v[144:147], v[144:147], 0
  v_mfma_f32_16x16x32_bf16 v[136:139], v[116:119], v[148:151], v[136:139]
  v_mfma_f32_16x16x32_bf16 v[140:143], v[148:151], v[148:151], v[140:143]
  v_mov_b32 v113, 0
  v_mov_b32 v115, 0
  v_cmp_eq_u32 vcc, 0, v27
  s_nop 1
  v_cndmask_b32 v113, v113, v108, vcc
  s_mov_b32 s72, 16384
  buffer_load_dwordx4 v[48:51], v1, s[60:63], s72 offen
  v_cndmask_b32 v115, v115, v140, vcc
  v_cmp_eq_u32 vcc, 1, v27
  s_nop 1
  v_cndmask_b32 v113, v113, v109, vcc
  v_cndmask_b32 v115, v115, v141, vcc
  v_cmp_eq_u32 vcc, 2, v27
  s_nop 1
  v_cndmask_b32 v113, v113, v110, vcc
  v_cndmask_b32 v115, v115, v142, vcc
  v_cmp_eq_u32 vcc, 3, v27
  s_nop 1
  v_cndmask_b32 v113, v113, v111, vcc
  v_cndmask_b32 v115, v115, v143, vcc
  s_mov_b32 s72, 24576
  buffer_load_dwordx4 v[52:55], v1, s[60:63], s72 offen
  v_permlane32_swap_b32 v113, v115
  v_add_f32 v113, v113, v115
  v_mov_b32 v115, v113
  s_nop 1
  v_permlane16_swap_b32 v113, v115
  v_add_f32 v113, v113, v115
  v_mov_b32 v115, v113
  s_nop 1
  v_permlane32_swap_b32 v113, v115
  v_add_f32_dpp v136, v136, v136 quad_perm:[1,0,3,2] row_mask:0xf bank_mask:0xf
  s_nop 0
  s_nop 0
  v_add_f32_dpp v115, v115, v115 quad_perm:[1,0,3,2] row_mask:0xf bank_mask:0xf
  v_add_f32_dpp v136, v136, v136 quad_perm:[2,3,0,1] row_mask:0xf bank_mask:0xf
  s_mov_b32 s72, 131072
  buffer_load_dwordx4 v[56:59], v1, s[60:63], s72 offen
  v_add_f32_dpp v115, v115, v115 quad_perm:[2,3,0,1] row_mask:0xf bank_mask:0xf
  v_add_f32_dpp v136, v136, v136 row_half_mirror row_mask:0xf bank_mask:0xf
  s_nop 0
  v_add_f32_dpp v115, v115, v115 row_half_mirror row_mask:0xf bank_mask:0xf
  v_cmp_eq_u32 vcc, 1, v32
  s_nop 1
  v_cndmask_b32 v104, v104, v136, vcc
  v_cndmask_b32 v105, v113, v115, vcc
  v_mul_f32 v104, 0x3b000000, v104
  v_mul_f32 v105, 0x3b000000, v105
  v_fma_f32 v105, -v104, v104, v105
  v_max_f32 v105, 0, v105
  s_mov_b32 s72, 139264
  buffer_load_dwordx4 v[60:63], v1, s[60:63], s72 offen
  v_cvt_pk_bf16_f32 v106, v104, v104
  v_lshlrev_b32 v106, 16, v106
  v_cvt_pk_bf16_f32 v107, v105, v105
  v_lshlrev_b32 v107, 16, v107
  v_add_f32 v107, 0x3727c5ac, v107
  v_cvt_pk_bf16_f32 v107, v107, v107
  v_lshlrev_b32 v107, 16, v107
  v_sqrt_f32 v107, v107
  s_nop 0
  v_cvt_pk_bf16_f32 v107, v107, v107
  v_lshlrev_b32 v107, 16, v107
  s_mov_b32 s72, 147456
  buffer_load_dwordx4 v[64:67], v1, s[60:63], s72 offen
  v_rcp_f32 v108, v107
  v_sub_f32 v110, v104, v106
  v_mul_f32 v110, v110, v108
  v_cvt_pk_bf16_f32 v110, v110, v110
  v_lshlrev_b32 v110, 16, v110
  v_mul_f32 v111, v105, v108
  v_mul_f32 v111, v111, v108
  v_cvt_pk_bf16_f32 v112, v111, v111
  v_lshlrev_b32 v112, 16, v112
  v_add_f32 v112, 0x3727c5ac, v112
  s_mov_b32 s72, 155648
  buffer_load_dwordx4 v[68:71], v1, s[60:63], s72 offen
  v_cvt_pk_bf16_f32 v112, v112, v112
  v_lshlrev_b32 v112, 16, v112
  v_sqrt_f32 v112, v112
  s_nop 0
  v_cvt_pk_bf16_f32 v112, v112, v112
  v_lshlrev_b32 v112, 16, v112
  v_rcp_f32 v112, v112
  v_fma_f32 v110, -v110, v107, -v106
  v_mul_f32_e64 v112, v108, v112
  v_readlane_b32 s32, v106, 0
  v_readlane_b32 s33, v106, 1
  s_mov_b32 s72, 262144
  buffer_load_dwordx4 v[72:75], v1, s[60:63], s72 offen
  v_readlane_b32 s34, v106, 2
  v_readlane_b32 s35, v106, 3
  v_readlane_b32 s36, v106, 4
  v_readlane_b32 s37, v106, 5
  v_readlane_b32 s38, v106, 6
  v_readlane_b32 s39, v106, 7
  v_readlane_b32 s40, v106, 8
  v_readlane_b32 s41, v106, 9
  v_readlane_b32 s42, v106, 10
  v_readlane_b32 s43, v106, 11
  s_mov_b32 s72, 270336
  buffer_load_dwordx4 v[76:79], v1, s[60:63], s72 offen
  v_readlane_b32 s44, v106, 12
  v_readlane_b32 s45, v106, 13
  v_readlane_b32 s46, v106, 14
  v_readlane_b32 s47, v106, 15
  s_waitcnt lgkmcnt(0)
  v_readfirstlane_b32 s7, v29
  v_lshlrev_b32 v120, 16, v152
  v_and_b32 v121, 0xffff0000, v152
  v_lshlrev_b32 v122, 16, v153
  v_and_b32 v123, 0xffff0000, v153
  s_mov_b32 s72, 278528
  buffer_load_dwordx4 v[80:83], v1, s[60:63], s72 offen
  v_lshlrev_b32 v124, 16, v154
  v_and_b32 v125, 0xffff0000, v154
  v_lshlrev_b32 v126, 16, v155
  v_and_b32 v127, 0xffff0000, v155
  v_lshlrev_b32 v128, 16, v156
  v_and_b32 v129, 0xffff0000, v156
  v_lshlrev_b32 v130, 16, v157
  v_and_b32 v131, 0xffff0000, v157
  v_lshlrev_b32 v132, 16, v158
  v_and_b32 v133, 0xffff0000, v158
  s_mov_b32 s72, 286720
  buffer_load_dwordx4 v[84:87], v1, s[60:63], s72 offen
  v_lshlrev_b32 v134, 16, v159
  v_and_b32 v135, 0xffff0000, v159
  v_subrev_f32 v120, s32, v120
  v_subrev_f32 v121, s33, v121
  v_subrev_f32 v122, s34, v122
  v_subrev_f32 v123, s35, v123
  v_subrev_f32 v124, s36, v124
  v_subrev_f32 v125, s37, v125
  v_subrev_f32 v126, s38, v126
  v_subrev_f32 v127, s39, v127
  s_mov_b32 s72, 393216
  buffer_load_dwordx4 v[88:91], v1, s[60:63], s72 offen
  v_subrev_f32 v128, s40, v128
  v_subrev_f32 v129, s41, v129
  v_subrev_f32 v130, s42, v130
  v_subrev_f32 v131, s43, v131
  v_subrev_f32 v132, s44, v132
  v_subrev_f32 v133, s45, v133
  v_subrev_f32 v134, s46, v134
  v_subrev_f32 v135, s47, v135
  v_readlane_b32 s32, v108, 0
  v_readlane_b32 s33, v108, 1
  s_mov_b32 s72, 401408
  buffer_load_dwordx4 v[92:95], v1, s[60:63], s72 offen
  v_readlane_b32 s34, v108, 2
  v_readlane_b32 s35, v108, 3
  v_readlane_b32 s36, v108, 4
  v_readlane_b32 s37, v108, 5
  v_readlane_b32 s38, v108, 6
  v_readlane_b32 s39, v108, 7
  v_readlane_b32 s40, v108, 8
  v_readlane_b32 s41, v108, 9
  v_readlane_b32 s42, v108, 10
  v_readlane_b32 s43, v108, 11
  s_mov_b32 s72, 409600
  buffer_load_dwordx4 v[96:99], v1, s[60:63], s72 offen
  v_readlane_b32 s44, v108, 12
  v_readlane_b32 s45, v108, 13
  v_readlane_b32 s46, v108, 14
  v_readlane_b32 s47, v108, 15
  v_cvt_pk_bf16_f32 v152, v120, v121
  v_cvt_pk_bf16_f32 v153, v122, v123
  v_cvt_pk_bf16_f32 v154, v124, v125
  v_cvt_pk_bf16_f32 v155, v126, v127
  v_cvt_pk_bf16_f32 v156, v128, v129
  v_cvt_pk_bf16_f32 v157, v130, v131
  s_mov_b32 s72, 417792
  buffer_load_dwordx4 v[100:103], v1, s[60:63], s72 offen
  v_cvt_pk_bf16_f32 v158, v132, v133
  v_cvt_pk_bf16_f32 v159, v134, v135
  v_lshlrev_b32 v120, 16, v152
  v_and_b32 v121, 0xffff0000, v152
  v_lshlrev_b32 v122, 16, v153
  v_and_b32 v123, 0xffff0000, v153
  v_lshlrev_b32 v124, 16, v154
  v_and_b32 v125, 0xffff0000, v154
  v_lshlrev_b32 v126, 16, v155
  v_and_b32 v127, 0xffff0000, v155
  v_lshlrev_b32 v128, 16, v156
  v_and_b32 v129, 0xffff0000, v156
  v_lshlrev_b32 v130, 16, v157
  v_and_b32 v131, 0xffff0000, v157
  v_lshlrev_b32 v132, 16, v158
  v_and_b32 v133, 0xffff0000, v158
  v_lshlrev_b32 v134, 16, v159
  v_and_b32 v135, 0xffff0000, v159
  v_mul_f32 v120, s32, v120
  v_mul_f32 v121, s33, v121
  v_mul_f32 v122, s34, v122
  v_mul_f32 v123, s35, v123
  v_mul_f32 v124, s36, v124
  v_mul_f32 v125, s37, v125
  v_mul_f32 v126, s38, v126
  v_mul_f32 v127, s39, v127
  v_mul_f32 v128, s40, v128
  v_mul_f32 v129, s41, v129
  v_mul_f32 v130, s42, v130
  v_mul_f32 v131, s43, v131
  v_mul_f32 v132, s44, v132
  v_mul_f32 v133, s45, v133
  v_mul_f32 v134, s46, v134
  v_mul_f32 v135, s47, v135
  v_cvt_pk_bf16_f32 v136, v120, v121
  v_cvt_pk_bf16_f32 v137, v122, v123
  v_cvt_pk_bf16_f32 v138, v124, v125
  v_cvt_pk_bf16_f32 v144, v126, v127
  v_cvt_pk_bf16_f32 v140, v128, v129
  v_cvt_pk_bf16_f32 v141, v130, v131
  v_cvt_pk_bf16_f32 v142, v132, v133
  v_cvt_pk_bf16_f32 v145, v134, v135
  v_mov_b32 v139, s7
  v_mov_b32 v143, s7
  v_mov_b32_e64 v147, s7
  buffer_store_dwordx4 v[136:139], v30, s[52:55], s16 offen sc1
  buffer_store_dwordx4 v[140:143], v30, s[52:55], s17 offen sc1
  buffer_store_dwordx4 v[144:147], v30, s[52:55], s18 offen sc1
  ds_write2_b32 v23, v106, v108 offset0:0 offset1:72
  ds_write2_b32 v23, v110, v112 offset0:144 offset1:216
  s_mov_b64 exec, 1
  ds_add_u32 v4, v33 offset:88
  s_mov_b64 exec, -1
  s_mov_b64 exec, 1
  ds_add_u32 v4, v33 offset:84
  s_mov_b64 exec, -1
  buffer_load_dwordx4 v[104:107], v3, s[24:27], 0 offen
  s_mov_b32 s72, 44032
  buffer_load_dwordx4 v[108:111], v3, s[24:27], s72 offen
  s_mov_b32 s72, 88064
  buffer_load_dwordx4 v[112:115], v3, s[24:27], s72 offen
  s_mov_b32 s72, 132096
  buffer_load_dwordx4 v[116:119], v3, s[24:27], s72 offen
  s_mov_b32 s72, 1024
  buffer_load_dwordx4 v[120:123], v3, s[24:27], s72 offen
  s_mov_b32 s72, 45056
  buffer_load_dwordx4 v[124:127], v3, s[24:27], s72 offen
  s_mov_b32 s72, 89088
  buffer_load_dwordx4 v[128:131], v3, s[24:27], s72 offen
  s_mov_b32 s72, 133120
  buffer_load_dwordx4 v[132:135], v3, s[24:27], s72 offen
  s_setprio 1
  s_cmp_lt_u32 s10, 5
  s_cbranch_scc0 SD_111
SL_110:
  s_sub_u32 s68, s68, 1
  s_cbranch_scc1 ST_112
  s_sleep 2
  ds_read_b128 v[6:9], v4 offset:16
  s_waitcnt lgkmcnt(0)
  v_min3_u32 v6, v6, v7, v8
  v_min_u32 v6, v6, v9
  s_nop 0
  v_readfirstlane_b32 s10, v6
  s_cmp_lt_u32 s10, 5
  s_cbranch_scc1 SL_110
SD_111:
  s_waitcnt vmcnt(23)
SL_113:
  ds_read_b32 v6, v4 offset:88
  s_waitcnt lgkmcnt(0)
  v_cmp_gt_u32 vcc, 8, v6
  s_cbranch_vccz SD_114
  s_sleep 2
  s_sub_u32 s68, s68, 1
  s_cbranch_scc0 SL_113
  s_mov_b32 s68, 0
SD_114:
  v_mov_b32_e64 v11, 6
  ds_write_b128 v13, v[40:43] offset:16384
  ds_write_b128 v13, v[44:47] offset:17408
  ds_write_b128 v13, v[48:51] offset:18432
  ds_write_b128 v13, v[52:55] offset:19456
  ds_write_b32 v5, v11
  s_waitcnt vmcnt(19)
  v_mov_b32 v11, 7
  ds_write_b128 v13, v[56:59] offset:32768
  ds_write_b128 v13, v[60:63] offset:33792
  ds_write_b128 v13, v[64:67] offset:34816
  ds_write_b128 v13, v[68:71] offset:35840
  ds_write_b32 v5, v11
  s_waitcnt vmcnt(15)
  s_cmp_lt_u32 s10, 5
  s_cbranch_scc0 SD_117
SL_116:
  s_sub_u32 s68, s68, 1
  s_cbranch_scc1 ST_118
  s_sleep 2
  ds_read_b128 v[6:9], v4 offset:16
  s_waitcnt lgkmcnt(0)
  v_min3_u32 v6, v6, v7, v8
  v_min_u32 v6, v6, v9
  s_nop 0
  v_readfirstlane_b32 s10, v6
  s_cmp_lt_u32 s10, 5
  s_cbranch_scc1 SL_116
SD_117:
  v_mov_b32_e64 v11, 8
  ds_write_b128 v12, v[72:75] offset:0
  ds_write_b128 v12, v[76:79] offset:1024
  ds_write_b128 v12, v[80:83] offset:2048
  ds_write_b128 v12, v[84:87] offset:3072
  ds_write_b32 v5, v11
  s_waitcnt vmcnt(11)
  s_cmp_lt_u32 s10, 5
  s_cbranch_scc0 SD_120
SL_119:
  s_sub_u32 s68, s68, 1
  s_cbranch_scc1 ST_121
  s_sleep 2
  ds_read_b128 v[6:9], v4 offset:16
  s_waitcnt lgkmcnt(0)
  v_min3_u32 v6, v6, v7, v8
  v_min_u32 v6, v6, v9
  s_nop 0
  v_readfirstlane_b32 s10, v6
  s_cmp_lt_u32 s10, 5
  s_cbranch_scc1 SL_119
SD_120:
  v_mov_b32_e64 v11, 9
  ds_write_b128 v12, v[88:91] offset:16384
  ds_write_b128 v12, v[92:95] offset:17408
  ds_write_b128 v12, v[96:99] offset:18432
  ds_write_b128 v12, v[100:103] offset:19456
  ds_write_b32 v5, v11
  s_cmp_lt_u32 s10, 5
  s_cbranch_scc0 SD_123
SL_122:
  s_sub_u32 s68, s68, 1
  s_cbranch_scc1 ST_124
  s_sleep 2
  ds_read_b128 v[6:9], v4 offset:16
  s_waitcnt lgkmcnt(0)
  v_min3_u32 v6, v6, v7, v8
  v_min_u32 v6, v6, v9
  s_nop 0
  v_readfirstlane_b32 s10, v6
  s_cmp_lt_u32 s10, 5
  s_cbranch_scc1 SL_122
SD_123:
  v_mov_b32 v11, 10
  ds_write_b32 v5, v11
  s_waitcnt vmcnt(4)
  s_cmp_lt_u32 s10, 5
  s_cbranch_scc0 SD_126
SL_125:
  s_sub_u32 s68, s68, 1
  s_cbranch_scc1 ST_127
  s_sleep 2
  ds_read_b128 v[6:9], v4 offset:16
  s_waitcnt lgkmcnt(0)
  v_min3_u32 v6, v6, v7, v8
  v_min_u32 v6, v6, v9
  s_nop 0
  v_readfirstlane_b32 s10, v6
  s_cmp_lt_u32 s10, 5
  s_cbranch_scc1 SL_125
SD_126:
  v_mov_b32_e64 v11, 11
  ds_write_b128 v12, v[104:107] offset:49152
  ds_write_b128 v12, v[108:111] offset:50176
  ds_write_b128 v12, v[112:115] offset:51200
  ds_write_b128 v12, v[116:119] offset:52224
  ds_write_b32 v5, v11
  ds_read_b64_tr_b16 v[104:105], v16 offset:49152
  ds_read_b64_tr_b16 v[106:107], v16 offset:49664
  ds_read_b64_tr_b16 v[108:109], v16 offset:50176
  ds_read_b64_tr_b16 v[110:111], v16 offset:50688
  ds_read_b64_tr_b16 v[112:113], v16 offset:51200
  ds_read_b64_tr_b16 v[114:115], v16 offset:51712
  ds_read_b64_tr_b16 v[116:117], v16 offset:52224
  ds_read_b64_tr_b16 v[118:119], v16 offset:52736
  s_waitcnt vmcnt(0)
  s_cmp_lt_u32 s10, 5
  s_cbranch_scc0 SD_129
SL_128:
  s_sub_u32 s68, s68, 1
  s_cbranch_scc1 ST_130
  s_sleep 2
  ds_read_b128 v[6:9], v4 offset:16
  s_waitcnt lgkmcnt(0)
  v_min3_u32 v6, v6, v7, v8
  v_min_u32 v6, v6, v9
  s_nop 0
  v_readfirstlane_b32 s10, v6
  s_cmp_lt_u32 s10, 5
  s_cbranch_scc1 SL_128
SD_129:
  v_mov_b32_e64 v11, 12
  ds_write_b128 v13, v[120:123] offset:0
  ds_write_b128 v13, v[124:127] offset:1024
  ds_write_b128 v13, v[128:131] offset:2048
  ds_write_b128 v13, v[132:135] offset:3072
  ds_write_b32 v5, v11
  ds_read_b64_tr_b16 v[120:121], v17 offset:0
  ds_read_b64_tr_b16 v[122:123], v17 offset:512
  ds_read_b64_tr_b16 v[124:125], v17 offset:1024
  ds_read_b64_tr_b16 v[126:127], v17 offset:1536
  ds_read_b64_tr_b16 v[128:129], v17 offset:2048
  ds_read_b64_tr_b16 v[130:131], v17 offset:2560
  ds_read_b64_tr_b16 v[132:133], v17 offset:3072
  ds_read_b64_tr_b16 v[134:135], v17 offset:3584
  s_setprio 3
  s_waitcnt lgkmcnt(0)
  v_mfma_f32_16x16x32_bf16 v[22:25], v[18:21], v[104:107], 0
  v_mfma_f32_16x16x32_bf16 v[22:25], v[18:21], v[108:111], v[22:25]
  v_mfma_f32_16x16x32_bf16 v[22:25], v[18:21], v[112:115], v[22:25]
  v_mfma_f32_16x16x32_bf16 v[22:25], v[18:21], v[116:119], v[22:25]
  v_mfma_f32_16x16x32_bf16 v[26:29], v[18:21], v[120:123], 0
  v_mfma_f32_16x16x32_bf16 v[26:29], v[18:21], v[124:127], v[26:29]
  v_mfma_f32_16x16x32_bf16 v[26:29], v[18:21], v[128:131], v[26:29]
  v_mfma_f32_16x16x32_bf16 v[26:29], v[18:21], v[132:135], v[26:29]
  s_setprio 1
SL_131:
  ds_read_b32 v6, v4 offset:108
  s_waitcnt lgkmcnt(0)
  v_cmp_gt_u32 vcc, 4, v6
  s_cbranch_vccz SD_132
  s_sleep 2
  s_sub_u32 s68, s68, 1
  s_cbranch_scc0 SL_131
  s_mov_b32 s68, 0
SD_132:
  v_add_u32_e64 v6, s12, v3
  s_mov_b32 s72, 2048
  buffer_load_dwordx4 v[136:139], v6, s[24:27], s72 offen
  s_mov_b32 s72, 46080
  buffer_load_dwordx4 v[140:143], v6, s[24:27], s72 offen
  s_mov_b32 s72, 90112
  buffer_load_dwordx4 v[144:147], v6, s[24:27], s72 offen
  s_mov_b32 s72, 134144
  buffer_load_dwordx4 v[148:151], v6, s[24:27], s72 offen
  s_mov_b32 s72, 704512
  buffer_load_dwordx4 v[152:155], v3, s[24:27], s72 offen
  s_mov_b32 s72, 748544
  buffer_load_dwordx4 v[156:159], v3, s[24:27], s72 offen
  s_mov_b32 s72, 792576
  buffer_load_dwordx4 v[160:163], v3, s[24:27], s72 offen
  s_mov_b32 s72, 836608
  buffer_load_dwordx4 v[164:167], v3, s[24:27], s72 offen
  s_mov_b32 s72, 705536
  buffer_load_dwordx4 v[40:43], v3, s[24:27], s72 offen
  s_mov_b32 s72, 749568
  buffer_load_dwordx4 v[44:47], v3, s[24:27], s72 offen
  s_mov_b32 s72, 793600
  buffer_load_dwordx4 v[48:51], v3, s[24:27], s72 offen
  s_mov_b32 s72, 837632
  buffer_load_dwordx4 v[52:55], v3, s[24:27], s72 offen
  v_add_u32_e64 v6, s12, v3
  s_mov_b32 s72, 706560
  buffer_load_dwordx4 v[56:59], v6, s[24:27], s72 offen
  s_mov_b32 s72, 750592
  buffer_load_dwordx4 v[60:63], v6, s[24:27], s72 offen
  s_mov_b32 s72, 794624
  buffer_load_dwordx4 v[64:67], v6, s[24:27], s72 offen
  s_mov_b32 s72, 838656
  buffer_load_dwordx4 v[68:71], v6, s[24:27], s72 offen
  v_add_u32_e64 v7, 0, v2
  buffer_load_dwordx4 v[72:75], v7, s[28:31], 0 offen
  v_add_u32 v7, 8192, v2
  buffer_load_dwordx4 v[76:79], v7, s[28:31], 0 offen
  v_add_u32 v7, 16384, v2
  buffer_load_dwordx4 v[80:83], v7, s[28:31], 0 offen
  v_add_u32 v7, 24576, v2
  buffer_load_dwordx4 v[84:87], v7, s[28:31], 0 offen
  s_mov_b32 s72, 98304
  buffer_load_dwordx4 v[88:91], v1, s[28:31], s72 offen
  s_mov_b32 s72, 106496
  buffer_load_dwordx4 v[92:95], v1, s[28:31], s72 offen
  s_mov_b32 s72, 114688
  buffer_load_dwordx4 v[96:99], v1, s[28:31], s72 offen
  s_mov_b32 s72, 122880
  buffer_load_dwordx4 v[100:103], v1, s[28:31], s72 offen
  s_mov_b32 s72, 229376
  buffer_load_dwordx4 v[104:107], v1, s[28:31], s72 offen
  s_mov_b32 s72, 237568
  buffer_load_dwordx4 v[108:111], v1, s[28:31], s72 offen
  s_mov_b32 s72, 245760
  buffer_load_dwordx4 v[112:115], v1, s[28:31], s72 offen
  s_mov_b32 s72, 253952
  buffer_load_dwordx4 v[116:119], v1, s[28:31], s72 offen
  s_mov_b32 s72, 360448
  buffer_load_dwordx4 v[120:123], v1, s[28:31], s72 offen
  s_mov_b32 s72, 368640
  buffer_load_dwordx4 v[124:127], v1, s[28:31], s72 offen
  s_mov_b32 s72, 376832
  buffer_load_dwordx4 v[128:131], v1, s[28:31], s72 offen
  s_mov_b32 s72, 385024
  buffer_load_dwordx4 v[132:135], v1, s[28:31], s72 offen
  s_cmp_lt_u32 s10, 10
  s_cbranch_scc0 SD_135
SL_134:
  s_sub_u32 s68, s68, 1
  s_cbranch_scc1 ST_136
  s_sleep 2
  ds_read_b128 v[6:9], v4 offset:16
  s_waitcnt lgkmcnt(0)
  v_min3_u32 v6, v6, v7, v8
  v_min_u32 v6, v6, v9
  s_nop 0
  v_readfirstlane_b32 s10, v6
  s_cmp_lt_u32 s10, 10
  s_cbranch_scc1 SL_134
SD_135:
  s_waitcnt vmcnt(28)
  s_cmp_lt_u32 s10, 6
  s_cbranch_scc0 SD_138
SL_137:
  s_sub_u32 s68, s68, 1
  s_cbranch_scc1 ST_139
  s_sleep 2
  ds_read_b128 v[6:9], v4 offset:16
  s_waitcnt lgkmcnt(0)
  v_min3_u32 v6, v6, v7, v8
  v_min_u32 v6, v6, v9
  s_nop 0
  v_readfirstlane_b32 s10, v6
  s_cmp_lt_u32 s10, 6
  s_cbranch_scc1 SL_137
SD_138:
  v_mov_b32 v11, 13
  ds_write_b128 v13, v[136:139] offset:16384
  ds_write_b128 v13, v[140:143] offset:17408
  ds_write_b128 v13, v[144:147] offset:18432
  ds_write_b128 v13, v[148:151] offset:19456
  ds_write_b32 v5, v11
  ds_read_b64_tr_b16 v[136:137], v17 offset:16384
  ds_read_b64_tr_b16 v[138:139], v17 offset:16896
  ds_read_b64_tr_b16 v[140:141], v17 offset:17408
  ds_read_b64_tr_b16 v[142:143], v17 offset:17920
  ds_read_b64_tr_b16 v[144:145], v17 offset:18432
  ds_read_b64_tr_b16 v[146:147], v17 offset:18944
  ds_read_b64_tr_b16 v[148:149], v17 offset:19456
  ds_read_b64_tr_b16 v[150:151], v17 offset:19968
  s_waitcnt vmcnt(24)
  s_cmp_lt_u32 s10, 7
  s_cbranch_scc0 SD_141
SL_140:
  s_sub_u32 s68, s68, 1
  s_cbranch_scc1 ST_142
  s_sleep 2
  ds_read_b128 v[6:9], v4 offset:16
  s_waitcnt lgkmcnt(0)
  v_min3_u32 v6, v6, v7, v8
  v_min_u32 v6, v6, v9
  s_nop 0
  v_readfirstlane_b32 s10, v6
  s_cmp_lt_u32 s10, 7
  s_cbranch_scc1 SL_140
SD_141:
  v_mov_b32_e64 v11, 14
  ds_write_b128 v13, v[152:155] offset:32768
  ds_write_b128 v13, v[156:159] offset:33792
  ds_write_b128 v13, v[160:163] offset:34816
  ds_write_b128 v13, v[164:167] offset:35840
  ds_write_b32 v5, v11
  ds_read_b64_tr_b16 v[152:153], v17 offset:32768
  ds_read_b64_tr_b16 v[154:155], v17 offset:33280
  ds_read_b64_tr_b16 v[156:157], v17 offset:33792
  ds_read_b64_tr_b16 v[158:159], v17 offset:34304
  ds_read_b64_tr_b16 v[160:161], v17 offset:34816
  ds_read_b64_tr_b16 v[162:163], v17 offset:35328
  ds_read_b64_tr_b16 v[164:165], v17 offset:35840
  ds_read_b64_tr_b16 v[166:167], v17 offset:36352
  s_waitcnt vmcnt(20)
  s_cmp_lt_u32 s10, 8
  s_cbranch_scc0 SD_144
SL_143:
  s_sub_u32 s68, s68, 1
  s_cbranch_scc1 ST_145
  s_sleep 2
  ds_read_b128 v[6:9], v4 offset:16
  s_waitcnt lgkmcnt(0)
  v_min3_u32 v6, v6, v7, v8
  v_min_u32 v6, v6, v9
  s_nop 0
  v_readfirstlane_b32 s10, v6
  s_cmp_lt_u32 s10, 8
  s_cbranch_scc1 SL_143
SD_144:
  v_mov_b32_e64 v11, 15
  ds_write_b128 v12, v[40:43] offset:0
  ds_write_b128 v12, v[44:47] offset:1024
  ds_write_b128 v12, v[48:51] offset:2048
  ds_write_b128 v12, v[52:55] offset:3072
  ds_write_b32 v5, v11
  ds_read_b64_tr_b16 v[40:41], v16 offset:0
  ds_read_b64_tr_b16 v[42:43], v16 offset:512
  ds_read_b64_tr_b16 v[44:45], v16 offset:1024
  ds_read_b64_tr_b16 v[46:47], v16 offset:1536
  ds_read_b64_tr_b16 v[48:49], v16 offset:2048
  ds_read_b64_tr_b16 v[50:51], v16 offset:2560
  ds_read_b64_tr_b16 v[52:53], v16 offset:3072
  ds_read_b64_tr_b16 v[54:55], v16 offset:3584
  s_waitcnt vmcnt(16)
  s_cmp_lt_u32 s10, 9
  s_cbranch_scc0 SD_147
SL_146:
  s_sub_u32 s68, s68, 1
  s_cbranch_scc1 ST_148
  s_sleep 2
  ds_read_b128 v[6:9], v4 offset:16
  s_waitcnt lgkmcnt(0)
  v_min3_u32 v6, v6, v7, v8
  v_min_u32 v6, v6, v9
  s_nop 0
  v_readfirstlane_b32 s10, v6
  s_cmp_lt_u32 s10, 9
  s_cbranch_scc1 SL_146
SD_147:
  v_mov_b32_e64 v11, 16
  ds_write_b128 v12, v[56:59] offset:16384
  ds_write_b128 v12, v[60:63] offset:17408
  ds_write_b128 v12, v[64:67] offset:18432
  ds_write_b128 v12, v[68:71] offset:19456
  ds_write_b32 v5, v11
  ds_read_b64_tr_b16 v[56:57], v16 offset:16384
  ds_read_b64_tr_b16 v[58:59], v16 offset:16896
  ds_read_b64_tr_b16 v[60:61], v16 offset:17408
  ds_read_b64_tr_b16 v[62:63], v16 offset:17920
  ds_read_b64_tr_b16 v[64:65], v16 offset:18432
  ds_read_b64_tr_b16 v[66:67], v16 offset:18944
  ds_read_b64_tr_b16 v[68:69], v16 offset:19456
  ds_read_b64_tr_b16 v[70:71], v16 offset:19968
  s_waitcnt vmcnt(12)
  s_cmp_lt_u32 s10, 10
  s_cbranch_scc0 SD_150
SL_149:
  s_sub_u32 s68, s68, 1
  s_cbranch_scc1 ST_151
  s_sleep 2
  ds_read_b128 v[6:9], v4 offset:16
  s_waitcnt lgkmcnt(0)
  v_min3_u32 v6, v6, v7, v8
  v_min_u32 v6, v6, v9
  s_nop 0
  v_readfirstlane_b32 s10, v6
  s_cmp_lt_u32 s10, 10
  s_cbranch_scc1 SL_149
SD_150:
  v_mov_b32_e64 v11, 17
  ds_write_b128 v12, v[72:75] offset:32768
  ds_write_b128 v12, v[76:79] offset:33792
  ds_write_b128 v12, v[80:83] offset:34816
  ds_write_b128 v12, v[84:87] offset:35840
  ds_write_b32 v5, v11
  s_setprio 3
  s_waitcnt lgkmcnt(0)
  v_mfma_f32_16x16x32_bf16 v[30:33], v[18:21], v[136:139], 0
  v_mfma_f32_16x16x32_bf16 v[30:33], v[18:21], v[140:143], v[30:33]
  v_mfma_f32_16x16x32_bf16 v[30:33], v[18:21], v[144:147], v[30:33]
  v_mfma_f32_16x16x32_bf16 v[30:33], v[18:21], v[148:151], v[30:33]
  v_mfma_f32_16x16x32_bf16 v[22:25], v[18:21], v[152:155], v[22:25]
  v_mfma_f32_16x16x32_bf16 v[22:25], v[18:21], v[156:159], v[22:25]
  v_mfma_f32_16x16x32_bf16 v[22:25], v[18:21], v[160:163], v[22:25]
  v_mfma_f32_16x16x32_bf16 v[22:25], v[18:21], v[164:167], v[22:25]
  v_mfma_f32_16x16x32_bf16 v[26:29], v[18:21], v[40:43], v[26:29]
  v_mfma_f32_16x16x32_bf16 v[26:29], v[18:21], v[44:47], v[26:29]
  v_mfma_f32_16x16x32_bf16 v[26:29], v[18:21], v[48:51], v[26:29]
  v_mfma_f32_16x16x32_bf16 v[26:29], v[18:21], v[52:55], v[26:29]
  v_mfma_f32_16x16x32_bf16 v[30:33], v[18:21], v[56:59], v[30:33]
  v_mfma_f32_16x16x32_bf16 v[30:33], v[18:21], v[60:63], v[30:33]
  v_mfma_f32_16x16x32_bf16 v[30:33], v[18:21], v[64:67], v[30:33]
  v_mfma_f32_16x16x32_bf16 v[30:33], v[18:21], v[68:71], v[30:33]
  v_lshlrev_b32 v6, 2, v0
  v_add_u32 v7, 158464, v6
  s_lshl_b32 s72, s15, 9
  v_add_u32 v8, s72, v7
  v_add_u32 v6, 157696, v6
  v_mov_b32 v9, 1
  s_mov_b64 exec, 0xffff
  ds_write2_b32 v8, v22, v23 offset0:0 offset1:16
  ds_write2_b32 v8, v26, v27 offset0:32 offset1:48
  ds_write2_b32 v8, v30, v31 offset0:64 offset1:80
  s_mov_b64 exec, 1
  ds_add_rtn_u32 v10, v4, v9 offset:132
  s_mov_b64 exec, -1
  ds_read2st64_b32 v[22:23], v7 offset0:0 offset1:2
  ds_read2st64_b32 v[24:25], v7 offset0:4 offset1:6
  ds_read2st64_b32 v[26:27], v7 offset0:1 offset1:3
  ds_read2st64_b32 v[28:29], v7 offset0:5 offset1:7
  s_waitcnt lgkmcnt(0)
  v_readfirstlane_b32 s72, v10
  v_add_f32 v22, v22, v23
  v_add_f32 v24, v24, v25
  v_add_f32 v22, v22, v24
  v_add_f32 v26, v26, v27
  v_add_f32 v28, v28, v29
  v_add_f32 v26, v26, v28
  s_cmp_eq_u32 s72, 3
  s_cbranch_scc0 CF_152
  ds_write_b32 v6, v22 offset:0
  ds_write_b32 v6, v26 offset:256
  ds_write_b32 v4, v9 offset:36
CF_152:
  s_setprio 1
  s_and_b32 s72, s4, 30
  s_lshr_b32 s73, s15, 1
  s_add_u32 s72, s72, s73
  s_mul_i32 s72, s72, 324608
  s_and_b32 s73, s15, 1
  s_lshl_b32 s73, s73, 8
  s_add_u32 s72, s72, s73
  s_add_u32 s72, s72, 307200
  s_add_u32 s73, s72, 0x1000
  v_lshrrev_b32 v6, 4, v0
  v_and_b32 v7, 15, v0
  v_lshlrev_b32 v6, 9, v6
  v_lshl_add_u32 v6, v7, 4, v6
SL_153:
  ds_read_b32 v7, v5 offset:192
  s_waitcnt lgkmcnt(0)
  v_cmp_gt_u32 vcc, 1, v7
  s_cbranch_vccz SD_154
  s_sleep 2
  s_sub_u32 s68, s68, 1
  s_cbranch_scc0 SL_153
  s_mov_b32 s68, 0
SD_154:
  buffer_load_dwordx4 v[72:75], v6, s[52:55], s72 offen offset:0 sc1
  buffer_load_dwordx4 v[76:79], v6, s[52:55], s72 offen offset:2048 sc1
  buffer_load_dwordx4 v[80:83], v6, s[52:55], s73 offen offset:0 sc1
  buffer_load_dwordx4 v[84:87], v6, s[52:55], s73 offen offset:2048 sc1
  s_waitcnt vmcnt(0)
  v_add_f32 v72, v72, v80
  v_add_f32 v73, v73, v81
  v_add_f32 v74, v74, v82
  v_add_f32 v75, v75, v83
  v_add_f32 v76, v76, v84
  v_add_f32 v77, v77, v85
  v_add_f32 v78, v78, v86
  v_add_f32 v79, v79, v87
  v_add_f32 v72, v72, v76
  v_add_f32 v73, v73, v77
  v_add_f32 v74, v74, v78
  v_add_f32 v75, v75, v79
  s_nop 0
  v_permlane32_swap_b32 v72, v74
  v_permlane32_swap_b32 v73, v75
  v_add_f32 v72, v72, v74
  v_add_f32 v73, v73, v75
  v_mov_b32 v74, v72
  v_mov_b32 v75, v73
  s_nop 0
  v_permlane16_swap_b32 v72, v74
  v_permlane16_swap_b32 v73, v75
  v_add_f32 v72, v72, v74
  v_add_f32 v73, v73, v75
  v_mul_f32 v72, 0x3b000000, v72
  v_mul_f32 v73, 0x3b000000, v73
  v_fma_f32 v73, -v72, v72, v73
  v_max_f32 v73, 0, v73
  v_cvt_pk_bf16_f32 v74, v72, v72
  v_lshlrev_b32 v74, 16, v74
  v_cvt_pk_bf16_f32 v75, v73, v73
  v_lshlrev_b32 v75, 16, v75
  v_add_f32 v75, 0x3727c5ac, v75
  v_cvt_pk_bf16_f32 v75, v75, v75
  v_lshlrev_b32 v75, 16, v75
  v_sqrt_f32 v75, v75
  s_nop 0
  v_cvt_pk_bf16_f32 v75, v75, v75
  v_lshlrev_b32 v75, 16, v75
  v_rcp_f32 v76, v75
  v_sub_f32 v74, 0, v74
  v_and_b32 v6, 15, v0
  v_lshrrev_b32 v7, 5, v0
  v_lshl_add_u32 v6, v6, 1, v7
  s_lshl_b32 s72, s15, 7
  s_add_u32 s72, s72, 161664
  v_lshl_add_u32 v6, v6, 2, s72
  v_mov_b32 v7, 1
  ds_write2st64_b32 v6, v74, v76 offset0:0 offset1:2
  ds_write_b32 v5, v7 offset:160
  s_waitcnt lgkmcnt(0)
SL_156:
  ds_read_b32 v6, v4 offset:108
  s_waitcnt lgkmcnt(0)
  v_cmp_gt_u32 vcc, 8, v6
  s_cbranch_vccz SD_157
  s_sleep 2
  s_sub_u32 s68, s68, 1
  s_cbranch_scc0 SL_156
  s_mov_b32 s68, 0
SD_157:
  s_nop 0
  s_mov_b32 s72, 491520
  buffer_load_dwordx4 v[136:139], v1, s[28:31], s72 offen
  s_mov_b32 s72, 499712
  buffer_load_dwordx4 v[140:143], v1, s[28:31], s72 offen
  s_mov_b32 s72, 507904
  buffer_load_dwordx4 v[144:147], v1, s[28:31], s72 offen
  s_mov_b32 s72, 516096
  buffer_load_dwordx4 v[148:151], v1, s[28:31], s72 offen
  s_mov_b32 s72, 622592
  buffer_load_dwordx4 v[152:155], v1, s[28:31], s72 offen
  s_mov_b32 s72, 630784
  buffer_load_dwordx4 v[156:159], v1, s[28:31], s72 offen
  s_mov_b32 s72, 638976
  buffer_load_dwordx4 v[160:163], v1, s[28:31], s72 offen
  s_mov_b32 s72, 647168
  buffer_load_dwordx4 v[164:167], v1, s[28:31], s72 offen
  s_mov_b32 s72, 753664
  buffer_load_dwordx4 v[40:43], v1, s[28:31], s72 offen
  s_mov_b32 s72, 761856
  buffer_load_dwordx4 v[44:47], v1, s[28:31], s72 offen
  s_mov_b32 s72, 770048
  buffer_load_dwordx4 v[48:51], v1, s[28:31], s72 offen
  s_mov_b32 s72, 778240
  buffer_load_dwordx4 v[52:55], v1, s[28:31], s72 offen
  s_mov_b32 s72, 884736
  buffer_load_dwordx4 v[56:59], v1, s[28:31], s72 offen
  s_mov_b32 s72, 892928
  buffer_load_dwordx4 v[60:63], v1, s[28:31], s72 offen
  s_mov_b32 s72, 901120
  buffer_load_dwordx4 v[64:67], v1, s[28:31], s72 offen
  s_mov_b32 s72, 909312
  buffer_load_dwordx4 v[68:71], v1, s[28:31], s72 offen
  s_mov_b32 s72, 1015808
  buffer_load_dwordx4 v[72:75], v1, s[28:31], s72 offen
  s_mov_b32 s72, 1024000
  buffer_load_dwordx4 v[76:79], v1, s[28:31], s72 offen
  s_mov_b32 s72, 1032192
  buffer_load_dwordx4 v[80:83], v1, s[28:31], s72 offen
  s_mov_b32 s72, 1040384
  buffer_load_dwordx4 v[84:87], v1, s[28:31], s72 offen
  s_cmp_lt_u32 s10, 14
  s_cbranch_scc0 SD_160
SL_159:
  s_sub_u32 s68, s68, 1
  s_cbranch_scc1 ST_161
  s_sleep 2
  ds_read_b128 v[6:9], v4 offset:16
  s_waitcnt lgkmcnt(0)
  v_min3_u32 v6, v6, v7, v8
  v_min_u32 v6, v6, v9
  s_nop 0
  v_readfirstlane_b32 s10, v6
  s_cmp_lt_u32 s10, 14
  s_cbranch_scc1 SL_159
SD_160:
  s_cmp_lt_u32 s10, 11
  s_cbranch_scc0 SD_163
SL_162:
  s_sub_u32 s68, s68, 1
  s_cbranch_scc1 ST_164
  s_sleep 2
  ds_read_b128 v[6:9], v4 offset:16
  s_waitcnt lgkmcnt(0)
  v_min3_u32 v6, v6, v7, v8
  v_min_u32 v6, v6, v9
  s_nop 0
  v_readfirstlane_b32 s10, v6
  s_cmp_lt_u32 s10, 11
  s_cbranch_scc1 SL_162
SD_163:
  v_mov_b32_e64 v11, 18
  ds_write_b128 v12, v[88:91] offset:49152
  ds_write_b128 v12, v[92:95] offset:50176
  ds_write_b128 v12, v[96:99] offset:51200
  ds_write_b128 v12, v[100:103] offset:52224
  ds_write_b32 v5, v11
  s_cmp_lt_u32 s10, 12
  s_cbranch_scc0 SD_166
SL_165:
  s_sub_u32 s68, s68, 1
  s_cbranch_scc1 ST_167
  s_sleep 2
  ds_read_b128 v[6:9], v4 offset:16
  s_waitcnt lgkmcnt(0)
  v_min3_u32 v6, v6, v7, v8
  v_min_u32 v6, v6, v9
  s_nop 0
  v_readfirstlane_b32 s10, v6
  s_cmp_lt_u32 s10, 12
  s_cbranch_scc1 SL_165
SD_166:
  v_mov_b32 v11, 19
  ds_write_b128 v13, v[104:107] offset:0
  ds_write_b128 v13, v[108:111] offset:1024
  ds_write_b128 v13, v[112:115] offset:2048
  ds_write_b128 v13, v[116:119] offset:3072
  ds_write_b32 v5, v11
  s_cmp_lt_u32 s10, 13
  s_cbranch_scc0 SD_169
SL_168:
  s_sub_u32 s68, s68, 1
  s_cbranch_scc1 ST_170
  s_sleep 2
  ds_read_b128 v[6:9], v4 offset:16
  s_waitcnt lgkmcnt(0)
  v_min3_u32 v6, v6, v7, v8
  v_min_u32 v6, v6, v9
  s_nop 0
  v_readfirstlane_b32 s10, v6
  s_cmp_lt_u32 s10, 13
  s_cbranch_scc1 SL_168
SD_169:
  v_mov_b32 v11, 20
  ds_write_b128 v13, v[120:123] offset:16384
  ds_write_b128 v13, v[124:127] offset:17408
  ds_write_b128 v13, v[128:131] offset:18432
  ds_write_b128 v13, v[132:135] offset:19456
  ds_write_b32 v5, v11
  s_waitcnt vmcnt(16)
  s_cmp_lt_u32 s10, 14
  s_cbranch_scc0 SD_172
SL_171:
  s_sub_u32 s68, s68, 1
  s_cbranch_scc1 ST_173
  s_sleep 2
  ds_read_b128 v[6:9], v4 offset:16
  s_waitcnt lgkmcnt(0)
  v_min3_u32 v6, v6, v7, v8
  v_min_u32 v6, v6, v9
  s_nop 0
  v_readfirstlane_b32 s10, v6
  s_cmp_lt_u32 s10, 14
  s_cbranch_scc1 SL_171
SD_172:
  v_mov_b32_e64 v11, 21
  ds_write_b128 v13, v[136:139] offset:32768
  ds_write_b128 v13, v[140:143] offset:33792
  ds_write_b128 v13, v[144:147] offset:34816
  ds_write_b128 v13, v[148:151] offset:35840
  ds_write_b32 v5, v11
  s_waitcnt vmcnt(12)
  s_cmp_lt_u32 s10, 15
  s_cbranch_scc0 SD_175
SL_174:
  s_sub_u32 s68, s68, 1
  s_cbranch_scc1 ST_176
  s_sleep 2
  ds_read_b128 v[6:9], v4 offset:16
  s_waitcnt lgkmcnt(0)
  v_min3_u32 v6, v6, v7, v8
  v_min_u32 v6, v6, v9
  s_nop 0
  v_readfirstlane_b32 s10, v6
  s_cmp_lt_u32 s10, 15
  s_cbranch_scc1 SL_174
SD_175:
  v_mov_b32_e64 v11, 22
  ds_write_b128 v12, v[152:155] offset:0
  ds_write_b128 v12, v[156:159] offset:1024
  ds_write_b128 v12, v[160:163] offset:2048
  ds_write_b128 v12, v[164:167] offset:3072
  ds_write_b32 v5, v11
  s_waitcnt vmcnt(8)
  s_cmp_lt_u32 s10, 16
  s_cbranch_scc0 SD_178
SL_177:
  s_sub_u32 s68, s68, 1
  s_cbranch_scc1 ST_179
  s_sleep 2
  ds_read_b128 v[6:9], v4 offset:16
  s_waitcnt lgkmcnt(0)
  v_min3_u32 v6, v6, v7, v8
  v_min_u32 v6, v6, v9
  s_nop 0
  v_readfirstlane_b32 s10, v6
  s_cmp_lt_u32 s10, 16
  s_cbranch_scc1 SL_177
SD_178:
  v_mov_b32_e64 v11, 23
  ds_write_b128 v12, v[40:43] offset:16384
  ds_write_b128 v12, v[44:47] offset:17408
  ds_write_b128 v12, v[48:51] offset:18432
  ds_write_b128 v12, v[52:55] offset:19456
  ds_write_b32 v5, v11
SL_180:
  ds_read_b32 v6, v4 offset:108
  s_waitcnt lgkmcnt(0)
  v_cmp_gt_u32 vcc, 12, v6
  s_cbranch_vccz SD_181
  s_sleep 2
  s_sub_u32 s68, s68, 1
  s_cbranch_scc0 SL_180
  s_mov_b32 s68, 0
SD_181:
  s_nop 0
  s_mov_b32 s72, 1146880
  buffer_load_dwordx4 v[88:91], v1, s[28:31], s72 offen
  s_mov_b32 s72, 1155072
  buffer_load_dwordx4 v[92:95], v1, s[28:31], s72 offen
  s_mov_b32 s72, 1163264
  buffer_load_dwordx4 v[96:99], v1, s[28:31], s72 offen
  s_mov_b32 s72, 1171456
  buffer_load_dwordx4 v[100:103], v1, s[28:31], s72 offen
  s_mov_b32 s72, 1277952
  buffer_load_dwordx4 v[104:107], v1, s[28:31], s72 offen
  s_mov_b32 s72, 1286144
  buffer_load_dwordx4 v[108:111], v1, s[28:31], s72 offen
  s_mov_b32 s72, 1294336
  buffer_load_dwordx4 v[112:115], v1, s[28:31], s72 offen
  s_mov_b32 s72, 1302528
  buffer_load_dwordx4 v[116:119], v1, s[28:31], s72 offen
  s_waitcnt vmcnt(12)
  s_cmp_lt_u32 s10, 17
  s_cbranch_scc0 SD_184
SL_183:
  s_sub_u32 s68, s68, 1
  s_cbranch_scc1 ST_185
  s_sleep 2
  ds_read_b128 v[6:9], v4 offset:16
  s_waitcnt lgkmcnt(0)
  v_min3_u32 v6, v6, v7, v8
  v_min_u32 v6, v6, v9
  s_nop 0
  v_readfirstlane_b32 s10, v6
  s_cmp_lt_u32 s10, 17
  s_cbranch_scc1 SL_183
SD_184:
  v_mov_b32_e64 v11, 24
  ds_write_b128 v12, v[56:59] offset:32768
  ds_write_b128 v12, v[60:63] offset:33792
  ds_write_b128 v12, v[64:67] offset:34816
  ds_write_b128 v12, v[68:71] offset:35840
  ds_write_b32 v5, v11
  s_waitcnt vmcnt(8)
  s_cmp_lt_u32 s10, 18
  s_cbranch_scc0 SD_187
SL_186:
  s_sub_u32 s68, s68, 1
  s_cbranch_scc1 ST_188
  s_sleep 2
  ds_read_b128 v[6:9], v4 offset:16
  s_waitcnt lgkmcnt(0)
  v_min3_u32 v6, v6, v7, v8
  v_min_u32 v6, v6, v9
  s_nop 0
  v_readfirstlane_b32 s10, v6
  s_cmp_lt_u32 s10, 18
  s_cbranch_scc1 SL_186
SD_187:
  v_mov_b32_e64 v11, 25
  ds_write_b128 v12, v[72:75] offset:49152
  ds_write_b128 v12, v[76:79] offset:50176
  ds_write_b128 v12, v[80:83] offset:51200
  ds_write_b128 v12, v[84:87] offset:52224
  ds_write_b32 v5, v11
  s_waitcnt vmcnt(4)
  s_cmp_lt_u32 s10, 19
  s_cbranch_scc0 SD_190
SL_189:
  s_sub_u32 s68, s68, 1
  s_cbranch_scc1 ST_191
  s_sleep 2
  ds_read_b128 v[6:9], v4 offset:16
  s_waitcnt lgkmcnt(0)
  v_min3_u32 v6, v6, v7, v8
  v_min_u32 v6, v6, v9
  s_nop 0
  v_readfirstlane_b32 s10, v6
  s_cmp_lt_u32 s10, 19
  s_cbranch_scc1 SL_189
SD_190:
  v_mov_b32_e64 v11, 26
  ds_write_b128 v13, v[88:91] offset:0
  ds_write_b128 v13, v[92:95] offset:1024
  ds_write_b128 v13, v[96:99] offset:2048
  ds_write_b128 v13, v[100:103] offset:3072
  ds_write_b32 v5, v11
  s_waitcnt vmcnt(0)
  s_cmp_lt_u32 s10, 20
  s_cbranch_scc0 SD_193
SL_192:
  s_sub_u32 s68, s68, 1
  s_cbranch_scc1 ST_194
  s_sleep 2
  ds_read_b128 v[6:9], v4 offset:16
  s_waitcnt lgkmcnt(0)
  v_min3_u32 v6, v6, v7, v8
  v_min_u32 v6, v6, v9
  s_nop 0
  v_readfirstlane_b32 s10, v6
  s_cmp_lt_u32 s10, 20
  s_cbranch_scc1 SL_192
SD_193:
  v_mov_b32_e64 v11, 27
  ds_write_b128 v13, v[104:107] offset:16384
  ds_write_b128 v13, v[108:111] offset:17408
  ds_write_b128 v13, v[112:115] offset:18432
  ds_write_b128 v13, v[116:119] offset:19456
  ds_write_b32 v5, v11
  s_cmp_lt_u32 s10, 21
  s_cbranch_scc0 SD_196
SL_195:
  s_sub_u32 s68, s68, 1
  s_cbranch_scc1 ST_197
  s_sleep 2
  ds_read_b128 v[6:9], v4 offset:16
  s_waitcnt lgkmcnt(0)
  v_min3_u32 v6, v6, v7, v8
  v_min_u32 v6, v6, v9
  s_nop 0
  v_readfirstlane_b32 s10, v6
  s_cmp_lt_u32 s10, 21
  s_cbranch_scc1 SL_195
SD_196:
  v_mov_b32 v11, 28
  ds_write_b32 v5, v11
  s_waitcnt lgkmcnt(0)
  s_endpgm
ST_112:
  s_mov_b32 s68, 0
  s_branch SD_111
ST_118:
  s_mov_b32 s68, 0
  s_branch SD_117
ST_121:
  s_mov_b32 s68, 0
  s_branch SD_120
ST_124:
  s_mov_b32 s68, 0
  s_branch SD_123
ST_127:
  s_mov_b32 s68, 0
  s_branch SD_126
ST_130:
  s_mov_b32 s68, 0
  s_branch SD_129
ST_136:
  s_mov_b32 s68, 0
  s_branch SD_135
ST_139:
  s_mov_b32 s68, 0
  s_branch SD_138
ST_142:
  s_mov_b32 s68, 0
  s_branch SD_141
ST_145:
  s_mov_b32 s68, 0
  s_branch SD_144
ST_148:
  s_mov_b32 s68, 0
  s_branch SD_147
ST_151:
  s_mov_b32 s68, 0
  s_branch SD_150
ST_161:
  s_mov_b32 s68, 0
  s_branch SD_160
ST_164:
  s_mov_b32 s68, 0
  s_branch SD_163
ST_167:
  s_mov_b32 s68, 0
  s_branch SD_166
ST_170:
  s_mov_b32 s68, 0
  s_branch SD_169
ST_173:
  s_mov_b32 s68, 0
  s_branch SD_172
ST_176:
  s_mov_b32 s68, 0
  s_branch SD_175
ST_179:
  s_mov_b32 s68, 0
  s_branch SD_178
ST_185:
  s_mov_b32 s68, 0
  s_branch SD_184
ST_188:
  s_mov_b32 s68, 0
  s_branch SD_187
ST_191:
  s_mov_b32 s68, 0
  s_branch SD_190
ST_194:
  s_mov_b32 s68, 0
  s_branch SD_193
ST_197:
  s_mov_b32 s68, 0
  s_branch SD_196
L_roleB:
  s_setprio 3
  s_sub_u32 s10, s3, 4
  s_lshr_b32 s11, s10, 1
  s_and_b32 s12, s10, 1
  s_lshl_b32 s74, s6, 2
  s_load_dword s13, s[30:31], s74
  s_load_dword s14, s[32:33], s74
  s_and_b32 s67, s4, 1
  s_lshl3_add_u32 s67, s67, s5
  s_mul_i32 s69, s4, 324608
  s_mov_b32 s68, 2097152
  s_mov_b32 s52, s48
  s_mov_b32 s53, s49
  s_mov_b32 s54, 0x01a00000
  s_mov_b32 s55, 0x20000
  s_lshl_b32 s72, s10, 6
  v_add_u32 v7, s72, v0
  v_mov_b32 v5, 0
  v_mov_b32 v1, 157184
  v_mov_b32 v2, 1
  v_and_b32 v3, 15, v0
  v_lshrrev_b32 v4, 4, v0
  s_mov_b32 s15, 0
  v_lshlrev_b32 v8, 3, v7
  v_sub_u32 v8, 2047, v8
  v_subrev_u32 v9, 0, v8
  v_cvt_f32_i32 v10, v9
  v_cvt_pk_bf16_f32 v10, v10, v10
  v_and_b32 v10, 0xffff, v10
  v_subrev_u32 v10, 0x4280, v10
  v_min_i32 v9, 0x80, v9
  v_max_i32 v10, v9, v10
  v_lshlrev_b32 v10, 2, v10
  v_add_u32 v20, 134176, v10
  v_subrev_u32 v9, 1, v8
  v_cvt_f32_i32 v10, v9
  v_cvt_pk_bf16_f32 v10, v10, v10
  v_and_b32 v10, 0xffff, v10
  v_subrev_u32 v10, 0x4280, v10
  v_min_i32 v9, 0x80, v9
  v_max_i32 v10, v9, v10
  v_lshlrev_b32 v10, 2, v10
  v_add_u32 v21, 134176, v10
  v_subrev_u32 v9, 2, v8
  v_cvt_f32_i32 v10, v9
  v_cvt_pk_bf16_f32 v10, v10, v10
  v_and_b32 v10, 0xffff, v10
  v_subrev_u32 v10, 0x4280, v10
  v_min_i32 v9, 0x80, v9
  v_max_i32 v10, v9, v10
  v_lshlrev_b32 v10, 2, v10
  v_add_u32 v22, 134176, v10
  v_subrev_u32 v9, 3, v8
  v_cvt_f32_i32 v10, v9
  v_cvt_pk_bf16_f32 v10, v10, v10
  v_and_b32 v10, 0xffff, v10
  v_subrev_u32 v10, 0x4280, v10
  v_min_i32 v9, 0x80, v9
  v_max_i32 v10, v9, v10
  v_lshlrev_b32 v10, 2, v10
  v_add_u32 v23, 134176, v10
  v_subrev_u32 v9, 4, v8
  v_cvt_f32_i32 v10, v9
  v_cvt_pk_bf16_f32 v10, v10, v10
  v_and_b32 v10, 0xffff, v10
  v_subrev_u32 v10, 0x4280, v10
  v_min_i32 v9, 0x80, v9
  v_max_i32 v10, v9, v10
  v_lshlrev_b32 v10, 2, v10
  v_add_u32 v24, 134176, v10
  v_subrev_u32 v9, 5, v8
  v_cvt_f32_i32 v10, v9
  v_cvt_pk_bf16_f32 v10, v10, v10
  v_and_b32 v10, 0xffff, v10
  v_subrev_u32 v10, 0x4280, v10
  v_min_i32 v9, 0x80, v9
  v_max_i32 v10, v9, v10
  v_lshlrev_b32 v10, 2, v10
  v_add_u32 v25, 134176, v10
  v_subrev_u32 v9, 6, v8
  v_cvt_f32_i32 v10, v9
  v_cvt_pk_bf16_f32 v10, v10, v10
  v_and_b32 v10, 0xffff, v10
  v_subrev_u32 v10, 0x4280, v10
  v_min_i32 v9, 0x80, v9
  v_max_i32 v10, v9, v10
  v_lshlrev_b32 v10, 2, v10
  v_add_u32 v26, 134176, v10
  v_subrev_u32 v9, 7, v8
  v_cvt_f32_i32 v10, v9
  v_cvt_pk_bf16_f32 v10, v10, v10
  v_and_b32 v10, 0xffff, v10
  v_subrev_u32 v10, 0x4280, v10
  v_min_i32 v9, 0x80, v9
  v_max_i32 v10, v9, v10
  v_lshlrev_b32 v10, 2, v10
  v_add_u32 v27, 134176, v10
  v_subrev_u32 v9, 8, v8
  v_cvt_f32_i32 v10, v9
  v_cvt_pk_bf16_f32 v10, v10, v10
  v_and_b32 v10, 0xffff, v10
  v_subrev_u32 v10, 0x4280, v10
  v_min_i32 v9, 0x80, v9
  v_max_i32 v10, v9, v10
  v_min_u32 v10, 672, v10
  v_lshlrev_b32 v10, 2, v10
  v_add_u32 v28, 134176, v10
  v_subrev_u32 v9, 9, v8
  v_cvt_f32_i32 v10, v9
  v_cvt_pk_bf16_f32 v10, v10, v10
  v_and_b32 v10, 0xffff, v10
  v_subrev_u32 v10, 0x4280, v10
  v_min_i32 v9, 0x80, v9
  v_max_i32 v10, v9, v10
  v_min_u32 v10, 672, v10
  v_lshlrev_b32 v10, 2, v10
  v_add_u32 v29, 134176, v10
  v_subrev_u32 v9, 10, v8
  v_cvt_f32_i32 v10, v9
  v_cvt_pk_bf16_f32 v10, v10, v10
  v_and_b32 v10, 0xffff, v10
  v_subrev_u32 v10, 0x4280, v10
  v_min_i32 v9, 0x80, v9
  v_max_i32 v10, v9, v10
  v_min_u32 v10, 672, v10
  v_lshlrev_b32 v10, 2, v10
  v_add_u32 v30, 134176, v10
  v_max_u32 v8, 1, v4
  v_sub_u32 v8, 6, v8
  v_lshlrev_b32 v9, v8, v3
  v_lshlrev_b32 v10, v8, 16
  v_lshlrev_b32 v11, 9, v4
  v_cmp_eq_u32 vcc, 1, v4
  s_nop 1
  s_nop 0
  v_cndmask_b32 v11, v11, 16, vcc
  s_mul_i32 s72, s10, 5632
  s_add_u32 s72, s72, 134176
  v_add3_u32 v31, v9, v11, s72
  v_mov_b32 v12, 248
  v_cmp_eq_u32 vcc, 3, v4
  s_nop 1
  v_cndmask_b32 v12, 0, v12, vcc
  v_add_u32 v32, v31, v12
  v_add_u32 v33, v31, v10
  v_add_u32 v34, v32, v10
  v_lshlrev_b32 v9, 2, v3
  v_lshl_add_u32 v9, v4, 9, v9
  s_add_u32 s72, s72, 2048
  v_add_u32 v35, s72, v9
  s_mul_i32 s72, s10, 5632
  s_add_u32 s72, s72, 134176
  v_lshlrev_b32 v42, 2, v0
  v_add_u32 v42, s72, v42
  v_mul_u32_u24 v43, 272, v3
  v_lshl_add_u32 v43, v4, 4, v43
  v_add_u32 v43, s72, v43
  v_add_u32 v156, 1088, v42
  v_add_u32 v157, 2176, v42
  v_add_u32 v158, 3264, v42
  v_lshl_add_u32 v159, v4, 5, s72
  s_waitcnt lgkmcnt(0)
  s_lshl_b32 s72, s13, 16
  s_and_b32 s73, s13, 0xffff0000
  s_cmp_eq_u32 s11, 0
  s_cselect_b32 s13, s72, s73
  v_mov_b32 v8, s13
  s_mov_b32 s72, 0x3fb8aa3b
  v_mul_f32 v9, s72, v8
  v_fma_f32 v10, v8, s72, -v9
  v_fmac_f32 v10, 0x32a57060, v8
  v_exp_f32 v9, v9
  v_mul_f32 v10, 0x3f317218, v10
  v_fmac_f32 v9, v9, v10
  v_cvt_pk_bf16_f32 v8, v9, v9
  v_lshlrev_b32 v8, 16, v8
  s_waitcnt vmcnt(0)
  s_setprio 3
  v_lshlrev_b32 v36, 16, v36
  v_lshlrev_b32 v37, 16, v37
  v_lshlrev_b32 v38, 16, v38
  v_lshlrev_b32 v39, 16, v39
  v_lshlrev_b32 v40, 16, v40
  v_lshlrev_b32 v41, 16, v41
  v_mul_f32 v36, v8, v36
  v_mul_f32 v37, v8, v37
  v_mul_f32 v38, v8, v38
  v_mul_f32 v39, v8, v39
  v_mul_f32 v36, 0x3fb8aa3b, v36
  v_mul_f32 v37, 0.15915494, v37
  v_mul_f32 v44, 0x41000000, v36
  v_mul_f32 v45, 0x41000000, v37
  v_fract_f32 v45, v45
  v_lshl_add_u32 v46, v0, 2, v42
  ds_write_b64 v46, v[44:45]
  ds_read_b128 v[124:127], v159 offset:0
  ds_read_b128 v[128:131], v159 offset:16
  ds_read_b128 v[132:135], v159 offset:128
  ds_read_b128 v[136:139], v159 offset:144
  ds_read_b128 v[140:143], v159 offset:256
  ds_read_b128 v[144:147], v159 offset:272
  ds_read_b128 v[148:151], v159 offset:384
  ds_read_b128 v[152:155], v159 offset:400
  v_cvt_f32_u32 v164, v3
  v_add_f32 v166, 0x41800000, v164
  v_mul_f32 v9, 0x40800000, v36
  v_mul_f32 v10, 0x40800000, v37
  v_exp_f32 v9, v9
  v_fract_f32 v10, v10
  v_cos_f32 v44, v10
  v_sin_f32 v46, v10
  v_mul_f32 v44, v9, v44
  v_mul_f32 v46, v9, v46
  v_mul_f32 v12, v40, v38
  v_mul_f32 v13, v40, v39
  v_fma_f32 v52, -v41, v39, v12
  v_fma_f32 v54, v41, v38, v13
  v_mul_f32 v12, v52, v44
  v_mul_f32 v13, v52, v46
  v_fma_f32 v53, -v54, v46, v12
  v_fma_f32 v55, v54, v44, v13
  v_mul_f32 v9, 0x3f800000, v36
  v_mul_f32 v10, 0x3f800000, v37
  v_exp_f32 v9, v9
  v_fract_f32 v10, v10
  v_cos_f32 v44, v10
  v_sin_f32 v46, v10
  v_mul_f32 v44, v9, v44
  v_mul_f32 v46, v9, v46
  v_mul_f32 v9, 0x43800000, v36
  v_mul_f32 v10, 0x43800000, v37
  v_exp_f32 v9, v9
  v_fract_f32 v10, v10
  v_cos_f32 v48, v10
  v_sin_f32 v50, v10
  v_mul_f32 v48, v9, v48
  v_mul_f32_e64 v50, v9, v50
  v_pk_mul_f32 v[12:13], v[52:53], v[44:45] op_sel_hi:[1,0]
  v_pk_mul_f32 v[14:15], v[52:53], v[46:47] op_sel_hi:[1,0]
  v_pk_fma_f32 v[56:57], v[54:55], v[46:47], v[12:13] op_sel_hi:[1,0,1] neg_lo:[1,0,0] neg_hi:[1,0,0]
  v_pk_fma_f32 v[58:59], v[54:55], v[44:45], v[14:15] op_sel_hi:[1,0,1]
  v_cvt_pk_bf16_f32 v100, v52, -v54
  v_cvt_pk_bf16_f32 v104, v53, -v55
  v_pk_mul_f32 v[12:13], v[56:57], v[44:45] op_sel_hi:[1,0]
  v_pk_mul_f32 v[14:15], v[56:57], v[46:47] op_sel_hi:[1,0]
  v_pk_fma_f32 v[60:61], v[58:59], v[46:47], v[12:13] op_sel_hi:[1,0,1] neg_lo:[1,0,0] neg_hi:[1,0,0]
  v_pk_fma_f32 v[62:63], v[58:59], v[44:45], v[14:15] op_sel_hi:[1,0,1]
  v_cvt_pk_bf16_f32 v101, v56, -v58
  v_cvt_pk_bf16_f32 v105, v57, -v59
  v_pk_mul_f32 v[12:13], v[60:61], v[44:45] op_sel_hi:[1,0]
  v_pk_mul_f32 v[14:15], v[60:61], v[46:47] op_sel_hi:[1,0]
  v_pk_fma_f32 v[64:65], v[62:63], v[46:47], v[12:13] op_sel_hi:[1,0,1] neg_lo:[1,0,0] neg_hi:[1,0,0]
  v_pk_fma_f32 v[66:67], v[62:63], v[44:45], v[14:15] op_sel_hi:[1,0,1]
  v_cvt_pk_bf16_f32 v102, v60, -v62
  v_cvt_pk_bf16_f32 v106, v61, -v63
  v_cvt_pk_bf16_f32 v103, v64, -v66
  v_cvt_pk_bf16_f32 v107, v65, -v67
  v_pk_mul_f32 v[12:13], v[52:53], v[48:49] op_sel_hi:[1,0]
  v_pk_mul_f32 v[14:15], v[52:53], v[50:51] op_sel_hi:[1,0]
  v_pk_fma_f32 v[56:57], v[54:55], v[50:51], v[12:13] op_sel_hi:[1,0,1] neg_lo:[1,0,0] neg_hi:[1,0,0]
  v_pk_fma_f32 v[58:59], v[54:55], v[48:49], v[14:15] op_sel_hi:[1,0,1]
  v_cvt_pk_bf16_f32 v108, v56, -v58
  v_cvt_pk_bf16_f32 v110, v57, -v59
  v_pk_mul_f32 v[12:13], v[60:61], v[48:49] op_sel_hi:[1,0]
  v_pk_mul_f32 v[14:15], v[60:61], v[50:51] op_sel_hi:[1,0]
  v_pk_fma_f32 v[64:65], v[62:63], v[50:51], v[12:13] op_sel_hi:[1,0,1] neg_lo:[1,0,0] neg_hi:[1,0,0]
  v_pk_fma_f32 v[66:67], v[62:63], v[48:49], v[14:15] op_sel_hi:[1,0,1]
  v_cvt_pk_bf16_f32 v109, v64, -v66
  v_cvt_pk_bf16_f32 v111, v65, -v67
  v_pk_mul_f32 v[12:13], v[56:57], v[48:49] op_sel_hi:[1,0]
  v_pk_mul_f32 v[14:15], v[56:57], v[50:51] op_sel_hi:[1,0]
  v_pk_fma_f32 v[52:53], v[58:59], v[50:51], v[12:13] op_sel_hi:[1,0,1] neg_lo:[1,0,0] neg_hi:[1,0,0]
  v_pk_fma_f32 v[54:55], v[58:59], v[48:49], v[14:15] op_sel_hi:[1,0,1]
  v_cvt_pk_bf16_f32 v112, v52, -v54
  v_cvt_pk_bf16_f32 v113, v53, -v55
  v_pk_mul_f32 v[12:13], v[52:53], v[48:49] op_sel_hi:[1,0]
  v_pk_mul_f32 v[14:15], v[52:53], v[50:51] op_sel_hi:[1,0]
  v_pk_fma_f32 v[56:57], v[54:55], v[50:51], v[12:13] op_sel_hi:[1,0,1] neg_lo:[1,0,0] neg_hi:[1,0,0]
  v_pk_fma_f32 v[58:59], v[54:55], v[48:49], v[14:15] op_sel_hi:[1,0,1]
  v_cvt_pk_bf16_f32 v114, v56, -v58
  v_cvt_pk_bf16_f32 v115, v57, -v59
  v_mul_f32 v9, 0x44000000, v36
  v_mul_f32 v10, 0x44000000, v37
  v_exp_f32 v9, v9
  v_fract_f32 v10, v10
  v_cos_f32 v44, v10
  v_sin_f32 v46, v10
  v_mul_f32 v44, v9, v44
  v_mul_f32 v46, v9, v46
  v_mov_b32 v53, v56
  v_mov_b32 v55, v58
  v_pk_mul_f32 v[12:13], v[52:53], v[44:45] op_sel_hi:[1,0]
  v_pk_mul_f32 v[14:15], v[52:53], v[46:47] op_sel_hi:[1,0]
  v_pk_fma_f32 v[56:57], v[54:55], v[46:47], v[12:13] op_sel_hi:[1,0,1] neg_lo:[1,0,0] neg_hi:[1,0,0]
  v_pk_fma_f32 v[58:59], v[54:55], v[44:45], v[14:15] op_sel_hi:[1,0,1]
  v_cvt_pk_bf16_f32 v116, v56, -v58
  v_cvt_pk_bf16_f32 v117, v57, -v59
  v_pk_mul_f32 v[12:13], v[56:57], v[44:45] op_sel_hi:[1,0]
  v_pk_mul_f32 v[14:15], v[56:57], v[46:47] op_sel_hi:[1,0]
  v_pk_fma_f32 v[52:53], v[58:59], v[46:47], v[12:13] op_sel_hi:[1,0,1] neg_lo:[1,0,0] neg_hi:[1,0,0]
  v_pk_fma_f32 v[54:55], v[58:59], v[44:45], v[14:15] op_sel_hi:[1,0,1]
  v_cvt_pk_bf16_f32 v118, v52, -v54
  v_cvt_pk_bf16_f32 v119, v53, -v55
  v_pk_mul_f32 v[12:13], v[52:53], v[44:45] op_sel_hi:[1,0]
  v_pk_mul_f32 v[14:15], v[52:53], v[46:47] op_sel_hi:[1,0]
  v_pk_fma_f32 v[56:57], v[54:55], v[46:47], v[12:13] op_sel_hi:[1,0,1] neg_lo:[1,0,0] neg_hi:[1,0,0]
  v_pk_fma_f32 v[58:59], v[54:55], v[44:45], v[14:15] op_sel_hi:[1,0,1]
  v_cvt_pk_bf16_f32 v120, v56, -v58
  s_waitcnt lgkmcnt(0)
  v_pk_mul_f32 v[44:45], v[124:125], v[164:165] op_sel_hi:[1,0]
  v_pk_mul_f32 v[46:47], v[126:127], v[164:165] op_sel_hi:[1,0]
  v_pk_mul_f32 v[48:49], v[128:129], v[164:165] op_sel_hi:[1,0]
  v_pk_mul_f32 v[50:51], v[130:131], v[164:165] op_sel_hi:[1,0]
  v_exp_f32 v44, v44
  v_cos_f32 v52, v45
  v_sin_f32 v53, v45
  v_exp_f32 v46, v46
  v_cos_f32 v54, v47
  v_sin_f32 v55, v47
  v_exp_f32 v48, v48
  v_cos_f32 v56, v49
  v_sin_f32 v57, v49
  v_exp_f32 v50, v50
  v_cos_f32 v58, v51
  v_sin_f32_e64 v59, v51
  v_pk_mul_f32 v[52:53], v[52:53], v[44:45] op_sel_hi:[1,0]
  v_pk_mul_f32 v[54:55], v[54:55], v[46:47] op_sel_hi:[1,0]
  v_pk_mul_f32 v[56:57], v[56:57], v[48:49] op_sel_hi:[1,0]
  v_pk_mul_f32 v[58:59], v[58:59], v[50:51] op_sel_hi:[1,0]
  v_cvt_pk_bf16_f32 v68, v52, v53
  v_cvt_pk_bf16_f32 v69, v54, v55
  v_cvt_pk_bf16_f32 v70, v56, v57
  v_cvt_pk_bf16_f32 v71, v58, v59
  v_pk_mul_f32 v[44:45], v[124:125], v[166:167] op_sel_hi:[1,0]
  v_pk_mul_f32 v[46:47], v[126:127], v[166:167] op_sel_hi:[1,0]
  v_pk_mul_f32 v[48:49], v[128:129], v[166:167] op_sel_hi:[1,0]
  v_pk_mul_f32 v[50:51], v[130:131], v[166:167] op_sel_hi:[1,0]
  v_exp_f32 v44, v44
  v_cos_f32 v52, v45
  v_sin_f32 v53, v45
  v_exp_f32 v46, v46
  v_cos_f32 v54, v47
  v_sin_f32 v55, v47
  v_exp_f32 v48, v48
  v_cos_f32 v56, v49
  v_sin_f32 v57, v49
  v_exp_f32 v50, v50
  v_cos_f32 v58, v51
  v_sin_f32 v59, v51
  v_pk_mul_f32 v[52:53], v[52:53], v[44:45] op_sel_hi:[1,0]
  v_pk_mul_f32 v[54:55], v[54:55], v[46:47] op_sel_hi:[1,0]
  v_pk_mul_f32 v[56:57], v[56:57], v[48:49] op_sel_hi:[1,0]
  v_pk_mul_f32 v[58:59], v[58:59], v[50:51] op_sel_hi:[1,0]
  v_cvt_pk_bf16_f32 v84, v52, v53
  v_cvt_pk_bf16_f32 v85, v54, v55
  v_cvt_pk_bf16_f32 v86, v56, v57
  v_cvt_pk_bf16_f32 v87, v58, v59
  v_pk_mul_f32 v[44:45], v[132:133], v[164:165] op_sel_hi:[1,0]
  v_pk_mul_f32 v[46:47], v[134:135], v[164:165] op_sel_hi:[1,0]
  v_pk_mul_f32 v[48:49], v[136:137], v[164:165] op_sel_hi:[1,0]
  v_pk_mul_f32 v[50:51], v[138:139], v[164:165] op_sel_hi:[1,0]
  v_exp_f32 v44, v44
  v_cos_f32 v52, v45
  v_sin_f32 v53, v45
  v_exp_f32 v46, v46
  v_cos_f32 v54, v47
  v_sin_f32 v55, v47
  v_exp_f32 v48, v48
  v_cos_f32 v56, v49
  v_sin_f32 v57, v49
  v_exp_f32 v50, v50
  v_cos_f32 v58, v51
  v_sin_f32 v59, v51
  v_pk_mul_f32 v[52:53], v[52:53], v[44:45] op_sel_hi:[1,0]
  v_pk_mul_f32 v[54:55], v[54:55], v[46:47] op_sel_hi:[1,0]
  v_pk_mul_f32 v[56:57], v[56:57], v[48:49] op_sel_hi:[1,0]
  v_pk_mul_f32 v[58:59], v[58:59], v[50:51] op_sel_hi:[1,0]
  v_cvt_pk_bf16_f32 v72, v52, v53
  v_cvt_pk_bf16_f32 v73, v54, v55
  v_cvt_pk_bf16_f32 v74, v56, v57
  v_cvt_pk_bf16_f32 v75, v58, v59
  v_pk_mul_f32 v[44:45], v[132:133], v[166:167] op_sel_hi:[1,0]
  v_pk_mul_f32 v[46:47], v[134:135], v[166:167] op_sel_hi:[1,0]
  v_pk_mul_f32 v[48:49], v[136:137], v[166:167] op_sel_hi:[1,0]
  v_pk_mul_f32 v[50:51], v[138:139], v[166:167] op_sel_hi:[1,0]
  v_exp_f32 v44, v44
  v_cos_f32 v52, v45
  v_sin_f32 v53, v45
  v_exp_f32 v46, v46
  v_cos_f32 v54, v47
  v_sin_f32 v55, v47
  v_exp_f32 v48, v48
  v_cos_f32 v56, v49
  v_sin_f32 v57, v49
  v_exp_f32 v50, v50
  v_cos_f32 v58, v51
  v_sin_f32 v59, v51
  v_pk_mul_f32 v[52:53], v[52:53], v[44:45] op_sel_hi:[1,0]
  v_pk_mul_f32 v[54:55], v[54:55], v[46:47] op_sel_hi:[1,0]
  v_pk_mul_f32 v[56:57], v[56:57], v[48:49] op_sel_hi:[1,0]
  v_pk_mul_f32 v[58:59], v[58:59], v[50:51] op_sel_hi:[1,0]
  v_cvt_pk_bf16_f32 v88, v52, v53
  v_cvt_pk_bf16_f32 v89, v54, v55
  v_cvt_pk_bf16_f32 v90, v56, v57
  v_cvt_pk_bf16_f32 v91, v58, v59
  v_pk_mul_f32 v[44:45], v[140:141], v[164:165] op_sel_hi:[1,0]
  v_pk_mul_f32 v[46:47], v[142:143], v[164:165] op_sel_hi:[1,0]
  v_pk_mul_f32 v[48:49], v[144:145], v[164:165] op_sel_hi:[1,0]
  v_pk_mul_f32 v[50:51], v[146:147], v[164:165] op_sel_hi:[1,0]
  v_exp_f32 v44, v44
  v_cos_f32 v52, v45
  v_sin_f32 v53, v45
  v_exp_f32 v46, v46
  v_cos_f32 v54, v47
  v_sin_f32 v55, v47
  v_exp_f32 v48, v48
  v_cos_f32 v56, v49
  v_sin_f32 v57, v49
  v_exp_f32 v50, v50
  v_cos_f32 v58, v51
  v_sin_f32 v59, v51
  v_pk_mul_f32 v[52:53], v[52:53], v[44:45] op_sel_hi:[1,0]
  v_pk_mul_f32 v[54:55], v[54:55], v[46:47] op_sel_hi:[1,0]
  v_pk_mul_f32 v[56:57], v[56:57], v[48:49] op_sel_hi:[1,0]
  v_pk_mul_f32 v[58:59], v[58:59], v[50:51] op_sel_hi:[1,0]
  v_cvt_pk_bf16_f32 v76, v52, v53
  v_cvt_pk_bf16_f32 v77, v54, v55
  v_cvt_pk_bf16_f32 v78, v56, v57
  v_cvt_pk_bf16_f32 v79, v58, v59
  v_pk_mul_f32 v[44:45], v[140:141], v[166:167] op_sel_hi:[1,0]
  v_pk_mul_f32 v[46:47], v[142:143], v[166:167] op_sel_hi:[1,0]
  v_pk_mul_f32 v[48:49], v[144:145], v[166:167] op_sel_hi:[1,0]
  v_pk_mul_f32 v[50:51], v[146:147], v[166:167] op_sel_hi:[1,0]
  v_exp_f32 v44, v44
  v_cos_f32 v52, v45
  v_sin_f32 v53, v45
  v_exp_f32 v46, v46
  v_cos_f32 v54, v47
  v_sin_f32 v55, v47
  v_exp_f32 v48, v48
  v_cos_f32 v56, v49
  v_sin_f32 v57, v49
  v_exp_f32 v50, v50
  v_cos_f32 v58, v51
  v_sin_f32 v59, v51
  v_pk_mul_f32 v[52:53], v[52:53], v[44:45] op_sel_hi:[1,0]
  v_pk_mul_f32 v[54:55], v[54:55], v[46:47] op_sel_hi:[1,0]
  v_pk_mul_f32 v[56:57], v[56:57], v[48:49] op_sel_hi:[1,0]
  v_pk_mul_f32 v[58:59], v[58:59], v[50:51] op_sel_hi:[1,0]
  v_cvt_pk_bf16_f32 v92, v52, v53
  v_cvt_pk_bf16_f32 v93, v54, v55
  v_cvt_pk_bf16_f32 v94, v56, v57
  v_cvt_pk_bf16_f32 v95, v58, v59
  s_getreg_b32 s51, hwreg(HW_REG_XCC_ID, 0, 4)
  s_and_b32 s51, s51, 7
  s_and_b32 s50, s4, 30
  s_mul_i32 s50, s50, 324608
  s_add_u32 s50, s50, 319488
  s_barrier
  s_setprio 1
  ds_read_b32 v8, v1 offset:100
  s_waitcnt lgkmcnt(0)
  v_readfirstlane_b32 s7, v8
  s_cmp_eq_u32 s10, 3
  s_cbranch_scc0 B_nox2
  s_load_dwordx16 s[16:31], s[48:49], s50 glc
B_nox2:
  s_xor_b32 s51, s7, s51
  v_mul_f32 v44, v148, v164
  v_mul_f32 v45, v149, v164
  v_mul_f32 v46, v150, v164
  v_mul_f32 v47, v151, v164
  v_mul_f32 v48, v152, v164
  v_mul_f32 v49, v153, v164
  v_mul_f32 v50, v154, v164
  v_mul_f32 v51, v155, v164
  v_exp_f32 v44, v44
  v_cos_f32 v52, v45
  v_sin_f32 v53, v45
  v_exp_f32 v46, v46
  v_cos_f32 v54, v47
  v_sin_f32 v55, v47
  v_exp_f32 v48, v48
  v_cos_f32 v56, v49
  v_sin_f32 v57, v49
  v_exp_f32 v50, v50
  v_cos_f32 v58, v51
  v_sin_f32 v59, v51
  v_mul_f32 v52, v52, v44
  v_mul_f32 v53, v53, v44
  v_mul_f32 v54, v54, v46
  v_mul_f32 v55, v55, v46
  v_mul_f32 v56, v56, v48
  v_mul_f32 v57, v57, v48
  v_mul_f32 v58, v58, v50
  v_mul_f32 v59, v59, v50
  v_cvt_pk_bf16_f32 v80, v52, v53
  v_cvt_pk_bf16_f32 v81, v54, v55
  v_cvt_pk_bf16_f32 v82, v56, v57
  v_cvt_pk_bf16_f32 v83, v58, v59
  v_mul_f32 v44, v148, v166
  v_mul_f32 v45, v149, v166
  v_mul_f32 v46, v150, v166
  v_mul_f32 v47, v151, v166
  v_mul_f32 v48, v152, v166
  v_mul_f32 v49, v153, v166
  v_mul_f32 v50, v154, v166
  v_mul_f32 v51, v155, v166
  v_exp_f32 v44, v44
  v_cos_f32 v52, v45
  v_sin_f32 v53, v45
  v_exp_f32 v46, v46
  v_cos_f32 v54, v47
  v_sin_f32 v55, v47
  v_exp_f32 v48, v48
  v_cos_f32 v56, v49
  v_sin_f32 v57, v49
  v_exp_f32 v50, v50
  v_cos_f32 v58, v51
  v_sin_f32 v59, v51
  v_mul_f32 v52, v52, v44
  v_mul_f32 v53, v53, v44
  v_mul_f32 v54, v54, v46
  v_mul_f32 v55, v55, v46
  v_mul_f32 v56, v56, v48
  v_mul_f32 v57, v57, v48
  v_mul_f32 v58, v58, v50
  v_mul_f32 v59, v59, v50
  v_cvt_pk_bf16_f32 v96, v52, v53
  v_cvt_pk_bf16_f32 v97, v54, v55
  v_cvt_pk_bf16_f32 v98, v56, v57
  v_cvt_pk_bf16_f32 v99, v58, v59
  s_barrier
  s_waitcnt lgkmcnt(0)
  s_cmp_eq_u32 s10, 3
  s_cbranch_scc0 B_xdone
B_xchk:
  s_mov_b32 s73, 0
  s_xor_b32 s16, s16, s51
  s_or_b32 s73, s73, s16
  s_xor_b32 s17, s17, s51
  s_or_b32 s73, s73, s17
  s_xor_b32 s18, s18, s51
  s_or_b32 s73, s73, s18
  s_xor_b32 s19, s19, s51
  s_or_b32 s73, s73, s19
  s_xor_b32 s20, s20, s51
  s_or_b32 s73, s73, s20
  s_xor_b32 s21, s21, s51
  s_or_b32 s73, s73, s21
  s_xor_b32 s22, s22, s51
  s_or_b32 s73, s73, s22
  s_xor_b32 s23, s23, s51
  s_or_b32 s73, s73, s23
  s_xor_b32 s24, s24, s51
  s_or_b32 s73, s73, s24
  s_xor_b32 s25, s25, s51
  s_or_b32 s73, s73, s25
  s_xor_b32 s26, s26, s51
  s_or_b32 s73, s73, s26
  s_xor_b32 s27, s27, s51
  s_or_b32 s73, s73, s27
  s_xor_b32 s28, s28, s51
  s_or_b32 s73, s73, s28
  s_xor_b32 s29, s29, s51
  s_or_b32 s73, s73, s29
  s_xor_b32 s30, s30, s51
  s_or_b32 s73, s73, s30
  s_xor_b32 s31, s31, s51
  s_or_b32 s73, s73, s31
  s_cmp_gt_u32 s73, 7
  s_cbranch_scc1 B_xretry
B_xok:
  s_cmp_eq_u32 s73, 0
  s_cselect_b32 s72, 1, 2
  v_mov_b32 v10, s72
  v_mov_b32_e64 v11, s7
  ds_write_b64 v1, v[10:11] offset:96
B_xdone:
  ds_write2_b32 v42, v100, v101 offset0:0 offset1:68
  ds_write2_b32 v42, v102, v103 offset0:136 offset1:204
  ds_write2_b32 v156, v104, v105 offset0:0 offset1:68
  ds_write2_b32 v156, v106, v107 offset0:136 offset1:204
  ds_write2_b32 v157, v108, v109 offset0:0 offset1:68
  ds_write2_b32 v157, v110, v111 offset0:136 offset1:204
  ds_write2_b32 v158, v112, v113 offset0:0 offset1:68
  ds_write2_b32 v158, v114, v115 offset0:136 offset1:204
  ds_read_b128 v[100:103], v43 offset:0
  ds_read_b128 v[104:107], v43 offset:64
  ds_read_b128 v[108:111], v43 offset:128
  ds_read_b128 v[112:115], v43 offset:192
  ds_write2_b32 v42, v116, v117 offset0:0 offset1:68
  ds_write2_b32 v42, v118, v119 offset0:136 offset1:204
  ds_write_b32 v156, v120
  ds_read_b128 v[116:119], v43 offset:0
  ds_read_b128 v[120:123], v43 offset:64
  ds_read_b128 v[124:127], v43 offset:128
  ds_read_b128 v[128:131], v43 offset:192
  s_waitcnt lgkmcnt(0)
  v_mfma_f32_16x16x32_bf16 v[132:135], v[100:103], v[68:71], 0
  v_mfma_f32_16x16x32_bf16 v[136:139], v[100:103], v[84:87], 0
  v_mfma_f32_16x16x32_bf16 v[132:135], v[104:107], v[72:75], v[132:135]
  v_mfma_f32_16x16x32_bf16 v[136:139], v[104:107], v[88:91], v[136:139]
  v_mfma_f32_16x16x32_bf16 v[132:135], v[108:111], v[76:79], v[132:135]
  v_mfma_f32_16x16x32_bf16 v[136:139], v[108:111], v[92:95], v[136:139]
  v_mfma_f32_16x16x32_bf16 v[132:135], v[112:115], v[80:83], v[132:135]
  v_mfma_f32_16x16x32_bf16 v[136:139], v[112:115], v[96:99], v[136:139]
  v_mfma_f32_16x16x32_bf16 v[140:143], v[116:119], v[68:71], 0
  v_mfma_f32_16x16x32_bf16 v[144:147], v[116:119], v[84:87], 0
  v_mfma_f32_16x16x32_bf16 v[140:143], v[120:123], v[72:75], v[140:143]
  v_mfma_f32_16x16x32_bf16 v[144:147], v[120:123], v[88:91], v[144:147]
  v_mfma_f32_16x16x32_bf16 v[140:143], v[124:127], v[76:79], v[140:143]
  v_mfma_f32_16x16x32_bf16 v[144:147], v[124:127], v[92:95], v[144:147]
  v_mfma_f32_16x16x32_bf16 v[140:143], v[128:131], v[80:83], v[140:143]
  v_mfma_f32_16x16x32_bf16 v[144:147], v[128:131], v[96:99], v[144:147]
  ds_write2_b32 v31, v132, v133 offset0:0 offset1:1
  ds_write2_b32 v32, v134, v135 offset0:2 offset1:3
  ds_write2_b32 v33, v136, v137 offset0:0 offset1:1
  ds_write2_b32 v34, v138, v139 offset0:2 offset1:3
  s_mov_b64 exec, 0xffffffff
  s_nop 2
  ds_write2_b32 v35, v140, v144 offset0:0 offset1:16
  s_mov_b64 exec, 0xffff
  ds_write2_b32 v35, v141, v145 offset0:32 offset1:48
  ds_write2_b32 v35, v142, v146 offset0:64 offset1:80
  ds_write2_b32 v35, v143, v147 offset0:96 offset1:112
  ds_write_b32 v42, v5 offset:2688
  s_mov_b64 exec, -1
  s_mov_b64 exec, 1
  ds_add_u32 v1, v2 offset:92
  s_mov_b64 exec, -1
  v_lshrrev_b32 v8, 1, v0
  v_lshlrev_b32 v9, 6, v8
  v_and_b32 v10, 1, v0
  v_lshl_add_u32 v9, v10, 4, v9
  s_lshr_b32 s72, s6, 1
  s_mul_i32 s72, s72, 24576
  s_and_b32 s73, s6, 1
  s_lshl_b32 s73, s73, 5
  s_add_u32 s72, s72, s73
  s_lshl_b32 s73, s10, 11
  s_add_u32 s72, s72, s73
  s_add_u32 s72, s72, 16777216
  s_add_u32 s73, s72, 8192
  s_add_u32 s74, s72, 16384
  v_mul_u32_u24 v10, 4608, v10
  v_lshl_add_u32 v10, v8, 5, v10
  s_lshl_b32 s75, s10, 10
  s_add_u32 s75, s75, 148480
  v_add_u32 v10, s75, v10
  v_lshlrev_b32 v8, 4, v7
  v_add_u32 v8, 114688, v8
  s_add_u32 s15, s15, 4
SL_198:
  ds_read_b32 v11, v1 offset:92
  s_waitcnt lgkmcnt(0)
  v_cmp_gt_u32 vcc, s15, v11
  s_cbranch_vccz SD_199
  s_sub_u32 s68, s68, 1
  s_cbranch_scc0 SL_198
  s_mov_b32 s68, 0
SD_199:
  ds_read2st64_b32 v[44:45], v20 offset0:0 offset1:22
  ds_read2st64_b32 v[46:47], v21 offset0:0 offset1:22
  ds_read2st64_b32 v[48:49], v22 offset0:0 offset1:22
  ds_read2st64_b32 v[50:51], v23 offset0:0 offset1:22
  ds_read2st64_b32 v[52:53], v24 offset0:0 offset1:22
  ds_read2st64_b32 v[54:55], v25 offset0:0 offset1:22
  ds_read2st64_b32 v[56:57], v26 offset0:0 offset1:22
  ds_read2st64_b32 v[58:59], v27 offset0:0 offset1:22
  ds_read2st64_b32 v[60:61], v28 offset0:0 offset1:22
  ds_read2st64_b32 v[62:63], v29 offset0:0 offset1:22
  ds_read2st64_b32 v[64:65], v30 offset0:0 offset1:22
  ds_read2st64_b32 v[68:69], v20 offset0:44 offset1:66
  ds_read2st64_b32 v[70:71], v21 offset0:44 offset1:66
  ds_read2st64_b32 v[72:73], v22 offset0:44 offset1:66
  ds_read2st64_b32 v[74:75], v23 offset0:44 offset1:66
  ds_read2st64_b32 v[76:77], v24 offset0:44 offset1:66
  ds_read2st64_b32 v[78:79], v25 offset0:44 offset1:66
  ds_read2st64_b32 v[80:81], v26 offset0:44 offset1:66
  ds_read2st64_b32 v[82:83], v27 offset0:44 offset1:66
  ds_read2st64_b32 v[84:85], v28 offset0:44 offset1:66
  ds_read2st64_b32 v[86:87], v29 offset0:44 offset1:66
  ds_read2st64_b32 v[88:89], v30 offset0:44 offset1:66
  s_mov_b64 exec, 1
  ds_add_u32 v1, v2 offset:92
  s_mov_b64 exec, -1
  v_lshrrev_b32 v16, 1, v3
  v_mul_u32_u24 v16, 4160, v16
  v_and_b32 v17, 1, v0
  v_lshl_add_u32 v16, v17, 4, v16
  v_add_u32 v16, 118784, v16
  v_lshrrev_b32 v17, 5, v0
  v_mul_u32_u24 v17, 4096, v17
  v_lshl_add_u32 v17, v0, 4, v17
  v_add_u32 v17, 147968, v17
  s_cmp_eq_u32 s10, 0
  s_cselect_b64 vcc, -1, 0
  v_cndmask_b32 v16, v17, v16, vcc
  v_mov_b32 v12, 0
  v_mov_b32 v13, 0
  v_mov_b32 v14, 0
  v_mov_b32 v15, 0
SL_201:
  ds_read_b32 v11, v1 offset:88
  s_waitcnt lgkmcnt(0)
  v_cmp_gt_u32 vcc, 8, v11
  s_cbranch_vccz SD_202
  s_sleep 1
  s_sub_u32 s68, s68, 1
  s_cbranch_scc0 SL_201
  s_mov_b32 s68, 0
SD_202:
  v_add_f32 v44, v44, v45
  v_add_f32 v45, v46, v47
  v_add_f32 v46, v48, v49
  v_add_f32 v47, v50, v51
  v_add_f32 v48, v52, v53
  v_add_f32 v49, v54, v55
  v_add_f32 v50, v56, v57
  v_add_f32 v51, v58, v59
  v_add_f32 v52, v60, v61
  v_add_f32 v53, v62, v63
  v_add_f32 v54, v64, v65
  v_cvt_pk_bf16_f32 v92, v44, v45
  v_cvt_pk_bf16_f32 v93, v46, v47
  v_cvt_pk_bf16_f32 v94, v48, v49
  v_cvt_pk_bf16_f32 v95, v50, v51
  ds_write_b128 v8, v[92:95] offset:0
  v_cvt_pk_bf16_f32 v96, v45, v46
  v_cvt_pk_bf16_f32 v97, v47, v48
  v_cvt_pk_bf16_f32 v98, v49, v50
  v_cvt_pk_bf16_f32 v99, v51, v52
  ds_write_b128 v8, v[96:99] offset:4160
  v_cvt_pk_bf16_f32 v100, v46, v47
  v_cvt_pk_bf16_f32 v101, v48, v49
  v_cvt_pk_bf16_f32 v102, v50, v51
  v_cvt_pk_bf16_f32 v103, v52, v53
  ds_write_b128 v8, v[100:103] offset:8320
  v_cvt_pk_bf16_f32 v104, v47, v48
  v_cvt_pk_bf16_f32 v105, v49, v50
  v_cvt_pk_bf16_f32 v106, v51, v52
  v_cvt_pk_bf16_f32 v107, v53, v54
  ds_write_b128 v8, v[104:107] offset:12480
  v_add_f32 v68, v68, v69
  v_add_f32 v69, v70, v71
  v_add_f32 v70, v72, v73
  v_add_f32 v71, v74, v75
  v_add_f32 v72, v76, v77
  v_add_f32 v73, v78, v79
  v_add_f32 v74, v80, v81
  v_add_f32 v75, v82, v83
  v_add_f32 v76, v84, v85
  v_add_f32 v77, v86, v87
  v_add_f32_e64 v78, v88, v89
  v_cvt_pk_bf16_f32 v108, v68, v69
  v_cvt_pk_bf16_f32 v109, v70, v71
  v_cvt_pk_bf16_f32 v110, v72, v73
  v_cvt_pk_bf16_f32 v111, v74, v75
  v_cvt_pk_bf16_f32 v112, v69, v70
  v_cvt_pk_bf16_f32 v113, v71, v72
  v_cvt_pk_bf16_f32 v114, v73, v74
  v_cvt_pk_bf16_f32 v115, v75, v76
  v_cvt_pk_bf16_f32 v116, v70, v71
  v_cvt_pk_bf16_f32 v117, v72, v73
  v_cvt_pk_bf16_f32 v118, v74, v75
  v_cvt_pk_bf16_f32 v119, v76, v77
  v_cvt_pk_bf16_f32 v120, v71, v72
  v_cvt_pk_bf16_f32 v121, v73, v74
  v_cvt_pk_bf16_f32 v122, v75, v76
  v_cvt_pk_bf16_f32 v123, v77, v78
  s_add_u32 s15, s15, 4
SL_204:
  ds_read_b32 v11, v1 offset:92
  s_waitcnt lgkmcnt(0)
  v_cmp_gt_u32 vcc, s15, v11
  s_cbranch_vccz SD_205
  s_sub_u32 s68, s68, 1
  s_cbranch_scc0 SL_204
  s_mov_b32 s68, 0
SD_205:
  ds_write_b128 v8, v[108:111] offset:16640
  ds_write_b128 v8, v[112:115] offset:20800
  ds_write_b128 v8, v[116:119] offset:24960
  ds_write_b128 v8, v[120:123] offset:29120
  s_cmp_ge_u32 s10, 2
  s_cbranch_scc1 B_nz
  ds_write_b128 v16, v[12:15]
B_nz:
  buffer_load_dwordx4 v[132:135], v9, s[52:55], s72 offen sc1
  buffer_load_dwordx4 v[136:139], v9, s[52:55], s73 offen sc1
  buffer_load_dwordx4 v[140:143], v9, s[52:55], s74 offen sc1
  s_waitcnt vmcnt(0)
  v_xor_b32 v135, s7, v135
  v_xor_b32 v139, s7, v139
  v_xor_b32 v143, s7, v143
  v_or3_b32 v135, v135, v139, v143
  v_cmp_ne_u32 vcc, 0, v135
  s_cbranch_vccz SD_208
SL_207:
  s_sub_u32 s68, s68, 1
  s_cbranch_scc1 ST_209
  buffer_load_dwordx4 v[132:135], v9, s[52:55], s72 offen sc1
  buffer_load_dwordx4 v[136:139], v9, s[52:55], s73 offen sc1
  buffer_load_dwordx4 v[140:143], v9, s[52:55], s74 offen sc1
  s_waitcnt vmcnt(0)
  v_xor_b32 v135, s7, v135
  v_xor_b32 v139, s7, v139
  v_xor_b32 v143, s7, v143
  v_or3_b32 v135, v135, v139, v143
  v_cmp_ne_u32 vcc, 0, v135
  s_cbranch_vccnz SL_207
SD_208:
  v_mov_b32 v135, v140
  v_mov_b32 v139, v141
  ds_write_b128 v10, v[132:135]
  ds_write_b128 v10, v[136:139] offset:16
  s_lshl_b32 s72, s10, 2
  v_add_u32 v22, s72, v1
  v_and_b32 v8, 3, v0
  v_sub_u32 v8, 3, v8
  v_mul_u32_u24 v8, 4160, v8
  v_lshl_add_u32 v8, v4, 4, v8
  v_lshrrev_b32 v9, 2, v3
  v_lshlrev_b32 v9, 3, v9
  v_sub_u32 v8, v8, v9
  s_mul_i32 s72, s11, 16640
  s_lshl_b32 s73, s12, 8
  s_sub_u32 s72, s72, s73
  s_add_u32 s72, s72, 114968
  v_add_u32 v20, s72, v8
  v_lshlrev_b32 v8, 5, v3
  s_mul_i32 s72, s11, 4608
  s_add_u32 s72, s72, 148256
  v_add_u32 v8, s72, v8
  v_lshl_add_u32 v21, v4, 4, v8
  v_subrev_u32 v21, s73, v21
  v_lshl_add_u32 v19, v4, 3, v8
  s_lshl_b32 s73, s12, 11
  v_add_u32 v19, s73, v19
  s_mul_i32 s72, s11, 16640
  s_lshl_b32 s73, s12, 12
  s_add_u32 s72, s72, 122880
  s_add_u32 s74, s72, s73
  v_lshl_add_u32 v12, v0, 4, s74
  s_xor_b32 s73, s73, 0x1000
  s_add_u32 s74, s72, s73
  v_lshl_add_u32 v13, v0, 4, s74
  v_xor_b32 v14, 4, v22
  s_lshl_b32 s70, s14, 16
  s_and_b32 s72, s14, 0xffff0000
  s_cmp_eq_u32 s11, 0
  s_cselect_b32 s70, s70, s72
  s_lshl1_add_u32 s73, s6, s11
  s_lshl_b32 s73, s73, 13
  s_add_u32 s73, s73, 20971520
  s_lshl_b32 s74, s12, 12
  s_add_u32 s73, s73, s74
  v_lshlrev_b32 v10, 6, v3
  v_lshl_add_u32 v10, v4, 4, v10
  s_mov_b64 exec, 1
  ds_add_u32 v1, v2 offset:92
  s_mov_b64 exec, -1
  s_add_u32 s15, s15, 4
SL_210:
  ds_read_b32 v11, v1 offset:92
  s_waitcnt lgkmcnt(0)
  v_cmp_gt_u32 vcc, s15, v11
  s_cbranch_vccz SD_211
  s_sub_u32 s68, s68, 1
  s_cbranch_scc0 SL_210
  s_mov_b32 s68, 0
SD_211:
  s_setprio 3
SL_213:
  ds_read_b32 v23, v22 offset:144
  s_waitcnt lgkmcnt(0)
  v_cmp_ne_u32 vcc, 0, v23
  s_cbranch_vccz SD_214
  s_sleep 1
  s_sub_u32 s68, s68, 1
  s_cbranch_scc0 SL_213
  s_mov_b32 s68, 0
SD_214:
  s_nop 0
  ds_read_b64 v[56:57], v20 offset:3776
  ds_read_b64 v[58:59], v20 offset:3784
  ds_read_b128 v[60:63], v21 offset:192
  ds_read_b64 v[64:65], v20 offset:3264
  ds_read_b64 v[66:67], v20 offset:3272
  ds_read_b128 v[68:71], v21 offset:704
  ds_read_b64 v[72:73], v20 offset:2752
  ds_read_b64 v[74:75], v20 offset:2760
  ds_read_b128 v[76:79], v21 offset:1216
  ds_read_b64 v[80:81], v20 offset:2240
  ds_read_b64 v[82:83], v20 offset:2248
  ds_read_b128 v[84:87], v21 offset:1728
  ds_read_b64 v[88:89], v20 offset:1728
  ds_read_b64 v[90:91], v20 offset:1736
  ds_read_b128 v[92:95], v21 offset:2240
  s_waitcnt lgkmcnt(12)
  v_mfma_f32_16x16x32_bf16 v[24:27], v[56:59], v[60:63], 0
  ds_read_b64 v[96:97], v20 offset:1216
  ds_read_b32 v23, v22 offset:144
  s_waitcnt lgkmcnt(11)
  v_mfma_f32_16x16x32_bf16 v[28:31], v[56:59], v[68:71], 0
  ds_read_b64 v[98:99], v20 offset:1224
  v_mfma_f32_16x16x32_bf16 v[28:31], v[64:67], v[60:63], v[28:31]
  ds_read_b128 v[100:103], v21 offset:2752
  v_mfma_f32_16x16x32_bf16 v[32:35], v[64:67], v[68:71], 0
  ds_read_b64 v[104:105], v20 offset:704
  s_waitcnt lgkmcnt(11)
  v_mfma_f32_16x16x32_bf16 v[32:35], v[56:59], v[76:79], v[32:35]
  ds_read_b64 v[106:107], v20 offset:712
  v_mfma_f32_16x16x32_bf16 v[36:39], v[64:67], v[76:79], 0
  ds_read_b128 v[108:111], v21 offset:3264
  s_waitcnt lgkmcnt(5)
  v_cmp_ne_u32 vcc, 0, v23
  s_cbranch_vccnz SL_216
SD_217:
  v_mfma_f32_16x16x32_bf16 v[32:35], v[72:75], v[60:63], v[32:35]
  ds_read_b64 v[112:113], v20 offset:192
  ds_read_b32 v23, v22 offset:144
  v_mfma_f32_16x16x32_bf16 v[36:39], v[72:75], v[68:71], v[36:39]
  ds_read_b64 v[114:115], v20 offset:200
  v_mfma_f32_16x16x32_bf16 v[40:43], v[72:75], v[76:79], 0
  ds_read_b128 v[116:119], v21 offset:3776
  v_mfma_f32_16x16x32_bf16 v[36:39], v[56:59], v[84:87], v[36:39]
  ds_read_b64 v[120:121], v20 offset:3712
  v_mfma_f32_16x16x32_bf16 v[40:43], v[64:67], v[84:87], v[40:43]
  ds_read_b64 v[122:123], v20 offset:3720
  v_mfma_f32_16x16x32_bf16 v[44:47], v[72:75], v[84:87], 0
  ds_read_b128 v[124:127], v21 offset:128
  s_waitcnt lgkmcnt(5)
  v_cmp_ne_u32 vcc, 0, v23
  s_cbranch_vccnz SL_219
SD_220:
  v_mfma_f32_16x16x32_bf16 v[36:39], v[80:83], v[60:63], v[36:39]
  ds_read_b64 v[128:129], v20 offset:3200
  ds_read_b32 v23, v22 offset:144
  v_mfma_f32_16x16x32_bf16 v[40:43], v[80:83], v[68:71], v[40:43]
  ds_read_b64 v[130:131], v20 offset:3208
  v_mfma_f32_16x16x32_bf16 v[44:47], v[80:83], v[76:79], v[44:47]
  ds_read_b128 v[132:135], v21 offset:640
  v_mfma_f32_16x16x32_bf16 v[48:51], v[80:83], v[84:87], 0
  ds_read_b64 v[136:137], v20 offset:2688
  v_mfma_f32_16x16x32_bf16 v[40:43], v[56:59], v[92:95], v[40:43]
  ds_read_b64 v[138:139], v20 offset:2696
  v_mfma_f32_16x16x32_bf16 v[44:47], v[64:67], v[92:95], v[44:47]
  ds_read_b128 v[140:143], v21 offset:1152
  s_waitcnt lgkmcnt(5)
  v_cmp_ne_u32 vcc, 0, v23
  s_cbranch_vccnz SL_222
SD_223:
  v_mfma_f32_16x16x32_bf16 v[48:51], v[72:75], v[92:95], v[48:51]
  ds_read_b64 v[144:145], v20 offset:2176
  ds_read_b32 v23, v22 offset:144
  v_mfma_f32_16x16x32_bf16 v[52:55], v[80:83], v[92:95], 0
  ds_read_b64 v[146:147], v20 offset:2184
  v_mfma_f32_16x16x32_bf16 v[40:43], v[88:91], v[60:63], v[40:43]
  ds_read_b128 v[148:151], v21 offset:1664
  v_mfma_f32_16x16x32_bf16 v[44:47], v[88:91], v[68:71], v[44:47]
  v_mfma_f32_16x16x32_bf16 v[48:51], v[88:91], v[76:79], v[48:51]
  v_mfma_f32_16x16x32_bf16 v[52:55], v[88:91], v[84:87], v[52:55]
  s_waitcnt lgkmcnt(2)
  v_cmp_ne_u32 vcc, 0, v23
  s_cbranch_vccnz SL_225
SD_226:
  v_mfma_f32_16x16x32_bf16 v[44:47], v[56:59], v[100:103], v[44:47]
  ds_read_b64 v[80:81], v20 offset:1664
  ds_read_b32 v23, v22 offset:144
  v_mfma_f32_16x16x32_bf16 v[48:51], v[64:67], v[100:103], v[48:51]
  ds_read_b64 v[82:83], v20 offset:1672
  v_mfma_f32_16x16x32_bf16 v[52:55], v[72:75], v[100:103], v[52:55]
  ds_read_b128 v[84:87], v21 offset:2176
  v_mfma_f32_16x16x32_bf16 v[44:47], v[96:99], v[60:63], v[44:47]
  ds_read_b64 v[88:89], v20 offset:1152
  v_mfma_f32_16x16x32_bf16 v[48:51], v[96:99], v[68:71], v[48:51]
  ds_read_b64 v[90:91], v20 offset:1160
  v_mfma_f32_16x16x32_bf16 v[52:55], v[96:99], v[76:79], v[52:55]
  ds_read_b128 v[92:95], v21 offset:2688
  s_waitcnt lgkmcnt(5)
  v_cmp_ne_u32 vcc, 0, v23
  s_cbranch_vccnz SL_228
SD_229:
  v_mfma_f32_16x16x32_bf16 v[48:51], v[56:59], v[108:111], v[48:51]
  ds_read_b64 v[72:73], v20 offset:640
  ds_read_b32 v23, v22 offset:144
  v_mfma_f32_16x16x32_bf16 v[52:55], v[64:67], v[108:111], v[52:55]
  ds_read_b64 v[74:75], v20 offset:648
  v_mfma_f32_16x16x32_bf16 v[48:51], v[104:107], v[60:63], v[48:51]
  ds_read_b128 v[76:79], v21 offset:3200
  v_mfma_f32_16x16x32_bf16 v[52:55], v[104:107], v[68:71], v[52:55]
  ds_read_b64 v[96:97], v20 offset:128
  v_mfma_f32_16x16x32_bf16 v[52:55], v[56:59], v[116:119], v[52:55]
  ds_read_b64 v[98:99], v20 offset:136
  v_mfma_f32_16x16x32_bf16 v[52:55], v[112:115], v[60:63], v[52:55]
  ds_read_b128 v[100:103], v21 offset:3712
  s_waitcnt lgkmcnt(5)
  v_cmp_ne_u32 vcc, 0, v23
  s_cbranch_vccnz SL_231
SD_232:
  v_mfma_f32_16x16x32_bf16 v[24:27], v[120:123], v[124:127], v[24:27]
  ds_read_b64 v[64:65], v20 offset:3648
  ds_read_b32 v23, v22 offset:144
  v_mfma_f32_16x16x32_bf16 v[28:31], v[120:123], v[132:135], v[28:31]
  ds_read_b64 v[66:67], v20 offset:3656
  v_mfma_f32_16x16x32_bf16 v[28:31], v[128:131], v[124:127], v[28:31]
  ds_read_b128 v[68:71], v21 offset:64
  v_mfma_f32_16x16x32_bf16 v[32:35], v[128:131], v[132:135], v[32:35]
  ds_read_b64 v[104:105], v20 offset:3136
  v_mfma_f32_16x16x32_bf16 v[32:35], v[120:123], v[140:143], v[32:35]
  ds_read_b64 v[106:107], v20 offset:3144
  v_mfma_f32_16x16x32_bf16 v[36:39], v[128:131], v[140:143], v[36:39]
  ds_read_b128 v[108:111], v21 offset:576
  s_waitcnt lgkmcnt(5)
  v_cmp_ne_u32 vcc, 0, v23
  s_cbranch_vccnz SL_234
SD_235:
  v_mfma_f32_16x16x32_bf16 v[32:35], v[136:139], v[124:127], v[32:35]
  ds_read_b64 v[56:57], v20 offset:2624
  ds_read_b32 v23, v22 offset:144
  v_mfma_f32_16x16x32_bf16 v[36:39], v[136:139], v[132:135], v[36:39]
  ds_read_b64 v[58:59], v20 offset:2632
  v_mfma_f32_16x16x32_bf16 v[40:43], v[136:139], v[140:143], v[40:43]
  ds_read_b128 v[60:63], v21 offset:1088
  v_mfma_f32_16x16x32_bf16 v[36:39], v[120:123], v[148:151], v[36:39]
  ds_read_b64 v[112:113], v20 offset:2112
  v_mfma_f32_16x16x32_bf16 v[40:43], v[128:131], v[148:151], v[40:43]
  ds_read_b64 v[114:115], v20 offset:2120
  v_mfma_f32_16x16x32_bf16 v[44:47], v[136:139], v[148:151], v[44:47]
  ds_read_b128 v[116:119], v21 offset:1600
  s_waitcnt lgkmcnt(5)
  v_cmp_ne_u32 vcc, 0, v23
  s_cbranch_vccnz SL_237
SD_238:
  v_mfma_f32_16x16x32_bf16 v[36:39], v[144:147], v[124:127], v[36:39]
  ds_read_b32 v23, v22 offset:144
  v_mfma_f32_16x16x32_bf16 v[40:43], v[144:147], v[132:135], v[40:43]
  v_mfma_f32_16x16x32_bf16 v[44:47], v[144:147], v[140:143], v[44:47]
  v_mfma_f32_16x16x32_bf16 v[48:51], v[144:147], v[148:151], v[48:51]
  v_mfma_f32_16x16x32_bf16 v[40:43], v[120:123], v[84:87], v[40:43]
  v_mfma_f32_16x16x32_bf16 v[44:47], v[128:131], v[84:87], v[44:47]
  s_waitcnt lgkmcnt(0)
  v_cmp_ne_u32 vcc, 0, v23
  s_cbranch_vccnz SL_240
SD_241:
  v_mfma_f32_16x16x32_bf16 v[48:51], v[136:139], v[84:87], v[48:51]
  ds_read_b32 v23, v22 offset:144
  v_mfma_f32_16x16x32_bf16 v[52:55], v[144:147], v[84:87], v[52:55]
  v_mfma_f32_16x16x32_bf16 v[40:43], v[80:83], v[124:127], v[40:43]
  v_mfma_f32_16x16x32_bf16 v[44:47], v[80:83], v[132:135], v[44:47]
  v_mfma_f32_16x16x32_bf16 v[48:51], v[80:83], v[140:143], v[48:51]
  v_mfma_f32_16x16x32_bf16 v[52:55], v[80:83], v[148:151], v[52:55]
  s_waitcnt lgkmcnt(0)
  v_cmp_ne_u32 vcc, 0, v23
  s_cbranch_vccnz SL_243
SD_244:
  v_mfma_f32_16x16x32_bf16 v[44:47], v[120:123], v[92:95], v[44:47]
  ds_read_b64 v[144:145], v20 offset:1600
  ds_read_b32 v23, v22 offset:144
  v_mfma_f32_16x16x32_bf16 v[48:51], v[128:131], v[92:95], v[48:51]
  ds_read_b64 v[146:147], v20 offset:1608
  v_mfma_f32_16x16x32_bf16 v[52:55], v[136:139], v[92:95], v[52:55]
  ds_read_b128 v[148:151], v21 offset:2112
  v_mfma_f32_16x16x32_bf16 v[44:47], v[88:91], v[124:127], v[44:47]
  ds_read_b64 v[80:81], v20 offset:1088
  v_mfma_f32_16x16x32_bf16 v[48:51], v[88:91], v[132:135], v[48:51]
  ds_read_b64 v[82:83], v20 offset:1096
  v_mfma_f32_16x16x32_bf16 v[52:55], v[88:91], v[140:143], v[52:55]
  ds_read_b128 v[84:87], v21 offset:2624
  s_waitcnt lgkmcnt(5)
  v_cmp_ne_u32 vcc, 0, v23
  s_cbranch_vccnz SL_246
SD_247:
  v_mfma_f32_16x16x32_bf16 v[48:51], v[120:123], v[76:79], v[48:51]
  ds_read_b64 v[136:137], v20 offset:576
  ds_read_b32 v23, v22 offset:144
  v_mfma_f32_16x16x32_bf16 v[52:55], v[128:131], v[76:79], v[52:55]
  ds_read_b64 v[138:139], v20 offset:584
  v_mfma_f32_16x16x32_bf16 v[48:51], v[72:75], v[124:127], v[48:51]
  ds_read_b128 v[140:143], v21 offset:3136
  v_mfma_f32_16x16x32_bf16 v[52:55], v[72:75], v[132:135], v[52:55]
  ds_read_b64 v[88:89], v20 offset:64
  v_mfma_f32_16x16x32_bf16 v[52:55], v[120:123], v[100:103], v[52:55]
  ds_read_b64 v[90:91], v20 offset:72
  v_mfma_f32_16x16x32_bf16 v[52:55], v[96:99], v[124:127], v[52:55]
  ds_read_b128 v[92:95], v21 offset:3648
  s_waitcnt lgkmcnt(5)
  v_cmp_ne_u32 vcc, 0, v23
  s_cbranch_vccnz SL_249
SD_250:
  v_mfma_f32_16x16x32_bf16 v[24:27], v[64:67], v[68:71], v[24:27]
  ds_read_b64 v[128:129], v20 offset:3584
  ds_read_b32 v23, v22 offset:144
  v_mfma_f32_16x16x32_bf16 v[28:31], v[64:67], v[108:111], v[28:31]
  ds_read_b64 v[130:131], v20 offset:3592
  v_mfma_f32_16x16x32_bf16 v[28:31], v[104:107], v[68:71], v[28:31]
  ds_read_b128 v[132:135], v21 offset:0
  v_mfma_f32_16x16x32_bf16 v[32:35], v[104:107], v[108:111], v[32:35]
  ds_read_b64 v[72:73], v20 offset:3072
  v_mfma_f32_16x16x32_bf16 v[32:35], v[64:67], v[60:63], v[32:35]
  ds_read_b64 v[74:75], v20 offset:3080
  v_mfma_f32_16x16x32_bf16 v[36:39], v[104:107], v[60:63], v[36:39]
  ds_read_b128 v[76:79], v21 offset:512
  s_waitcnt lgkmcnt(5)
  v_cmp_ne_u32 vcc, 0, v23
  s_cbranch_vccnz SL_252
SD_253:
  v_mfma_f32_16x16x32_bf16 v[32:35], v[56:59], v[68:71], v[32:35]
  ds_read_b64 v[120:121], v20 offset:2560
  ds_read_b32 v23, v22 offset:144
  v_mfma_f32_16x16x32_bf16 v[36:39], v[56:59], v[108:111], v[36:39]
  ds_read_b64 v[122:123], v20 offset:2568
  v_mfma_f32_16x16x32_bf16 v[40:43], v[56:59], v[60:63], v[40:43]
  ds_read_b128 v[124:127], v21 offset:1024
  v_mfma_f32_16x16x32_bf16 v[36:39], v[64:67], v[116:119], v[36:39]
  ds_read_b64 v[96:97], v20 offset:2048
  v_mfma_f32_16x16x32_bf16 v[40:43], v[104:107], v[116:119], v[40:43]
  ds_read_b64 v[98:99], v20 offset:2056
  v_mfma_f32_16x16x32_bf16 v[44:47], v[56:59], v[116:119], v[44:47]
  ds_read_b128 v[100:103], v21 offset:1536
  s_waitcnt lgkmcnt(5)
  v_cmp_ne_u32 vcc, 0, v23
  s_cbranch_vccnz SL_255
SD_256:
  v_mfma_f32_16x16x32_bf16 v[36:39], v[112:115], v[68:71], v[36:39]
  ds_read_b32 v23, v22 offset:144
  v_mfma_f32_16x16x32_bf16 v[40:43], v[112:115], v[108:111], v[40:43]
  v_mfma_f32_16x16x32_bf16 v[44:47], v[112:115], v[60:63], v[44:47]
  v_mfma_f32_16x16x32_bf16 v[48:51], v[112:115], v[116:119], v[48:51]
  v_mfma_f32_16x16x32_bf16 v[40:43], v[64:67], v[148:151], v[40:43]
  v_mfma_f32_16x16x32_bf16 v[44:47], v[104:107], v[148:151], v[44:47]
  s_waitcnt lgkmcnt(0)
  v_cmp_ne_u32 vcc, 0, v23
  s_cbranch_vccnz SL_258
SD_259:
  v_mfma_f32_16x16x32_bf16 v[48:51], v[56:59], v[148:151], v[48:51]
  ds_read_b32 v23, v22 offset:144
  v_mfma_f32_16x16x32_bf16 v[52:55], v[112:115], v[148:151], v[52:55]
  v_mfma_f32_16x16x32_bf16 v[40:43], v[144:147], v[68:71], v[40:43]
  v_mfma_f32_16x16x32_bf16 v[44:47], v[144:147], v[108:111], v[44:47]
  v_mfma_f32_16x16x32_bf16 v[48:51], v[144:147], v[60:63], v[48:51]
  v_mfma_f32_16x16x32_bf16 v[52:55], v[144:147], v[116:119], v[52:55]
  s_waitcnt lgkmcnt(0)
  v_cmp_ne_u32 vcc, 0, v23
  s_cbranch_vccnz SL_261
SD_262:
  v_mfma_f32_16x16x32_bf16 v[44:47], v[64:67], v[84:87], v[44:47]
  ds_read_b64 v[112:113], v20 offset:1536
  ds_read_b32 v23, v22 offset:144
  v_mfma_f32_16x16x32_bf16 v[48:51], v[104:107], v[84:87], v[48:51]
  ds_read_b64 v[114:115], v20 offset:1544
  v_mfma_f32_16x16x32_bf16 v[52:55], v[56:59], v[84:87], v[52:55]
  ds_read_b128 v[116:119], v21 offset:2048
  v_mfma_f32_16x16x32_bf16 v[44:47], v[80:83], v[68:71], v[44:47]
  ds_read_b64 v[144:145], v20 offset:1024
  v_mfma_f32_16x16x32_bf16 v[48:51], v[80:83], v[108:111], v[48:51]
  ds_read_b64 v[146:147], v20 offset:1032
  v_mfma_f32_16x16x32_bf16 v[52:55], v[80:83], v[60:63], v[52:55]
  ds_read_b128 v[148:151], v21 offset:2560
  s_waitcnt lgkmcnt(5)
  v_cmp_ne_u32 vcc, 0, v23
  s_cbranch_vccnz SL_264
SD_265:
  v_mfma_f32_16x16x32_bf16 v[48:51], v[64:67], v[140:143], v[48:51]
  ds_read_b64 v[56:57], v20 offset:512
  ds_read_b32 v23, v22 offset:144
  v_mfma_f32_16x16x32_bf16 v[52:55], v[104:107], v[140:143], v[52:55]
  ds_read_b64 v[58:59], v20 offset:520
  v_mfma_f32_16x16x32_bf16 v[48:51], v[136:139], v[68:71], v[48:51]
  ds_read_b128 v[60:63], v21 offset:3072
  v_mfma_f32_16x16x32_bf16 v[52:55], v[136:139], v[108:111], v[52:55]
  ds_read_b64 v[80:81], v20 offset:0
  v_mfma_f32_16x16x32_bf16 v[52:55], v[64:67], v[92:95], v[52:55]
  ds_read_b64 v[82:83], v20 offset:8
  v_mfma_f32_16x16x32_bf16 v[52:55], v[88:91], v[68:71], v[52:55]
  ds_read_b128 v[84:87], v21 offset:3584
  s_waitcnt lgkmcnt(5)
  v_cmp_ne_u32 vcc, 0, v23
  s_cbranch_vccnz SL_267
SD_268:
  v_mfma_f32_16x16x32_bf16 v[24:27], v[128:131], v[132:135], v[24:27]
  ds_read_b64 v[152:153], v19 offset:224
  ds_read_b32 v23, v22 offset:144
  v_mfma_f32_16x16x32_bf16 v[28:31], v[128:131], v[76:79], v[28:31]
  ds_read_b64 v[154:155], v19 offset:736
  v_mfma_f32_16x16x32_bf16 v[28:31], v[72:75], v[132:135], v[28:31]
  ds_read_b64 v[156:157], v19 offset:1248
  v_mfma_f32_16x16x32_bf16 v[32:35], v[72:75], v[76:79], v[32:35]
  ds_read_b64 v[158:159], v19 offset:1760
  v_mfma_f32_16x16x32_bf16 v[32:35], v[128:131], v[124:127], v[32:35]
  v_mfma_f32_16x16x32_bf16 v[36:39], v[72:75], v[124:127], v[36:39]
  s_waitcnt lgkmcnt(3)
  v_cmp_ne_u32 vcc, 0, v23
  s_cbranch_vccnz SL_270
SD_271:
  v_mfma_f32_16x16x32_bf16 v[32:35], v[120:123], v[132:135], v[32:35]
  ds_read_b32 v23, v22 offset:144
  v_mfma_f32_16x16x32_bf16 v[36:39], v[120:123], v[76:79], v[36:39]
  v_mfma_f32_16x16x32_bf16 v[40:43], v[120:123], v[124:127], v[40:43]
  v_mfma_f32_16x16x32_bf16 v[36:39], v[128:131], v[100:103], v[36:39]
  v_mfma_f32_16x16x32_bf16 v[40:43], v[72:75], v[100:103], v[40:43]
  v_mfma_f32_16x16x32_bf16 v[44:47], v[120:123], v[100:103], v[44:47]
  s_waitcnt lgkmcnt(0)
  v_cmp_ne_u32 vcc, 0, v23
  s_cbranch_vccnz SL_273
SD_274:
  v_mfma_f32_16x16x32_bf16 v[36:39], v[96:99], v[132:135], v[36:39]
  ds_read_b32 v23, v22 offset:144
  v_mfma_f32_16x16x32_bf16 v[40:43], v[96:99], v[76:79], v[40:43]
  v_mfma_f32_16x16x32_bf16 v[44:47], v[96:99], v[124:127], v[44:47]
  v_mfma_f32_16x16x32_bf16 v[48:51], v[96:99], v[100:103], v[48:51]
  v_mfma_f32_16x16x32_bf16 v[40:43], v[128:131], v[116:119], v[40:43]
  v_mfma_f32_16x16x32_bf16 v[44:47], v[72:75], v[116:119], v[44:47]
  s_waitcnt lgkmcnt(0)
  v_cmp_ne_u32 vcc, 0, v23
  s_cbranch_vccnz SL_276
SD_277:
  v_mfma_f32_16x16x32_bf16 v[48:51], v[120:123], v[116:119], v[48:51]
  ds_read_b32 v23, v22 offset:144
  v_mfma_f32_16x16x32_bf16 v[52:55], v[96:99], v[116:119], v[52:55]
  v_mfma_f32_16x16x32_bf16 v[40:43], v[112:115], v[132:135], v[40:43]
  v_mfma_f32_16x16x32_bf16 v[44:47], v[112:115], v[76:79], v[44:47]
  v_mfma_f32_16x16x32_bf16 v[48:51], v[112:115], v[124:127], v[48:51]
  v_mfma_f32_16x16x32_bf16 v[52:55], v[112:115], v[100:103], v[52:55]
  s_waitcnt lgkmcnt(0)
  v_cmp_ne_u32 vcc, 0, v23
  s_cbranch_vccnz SL_279
SD_280:
  v_mfma_f32_16x16x32_bf16 v[44:47], v[128:131], v[148:151], v[44:47]
  ds_read_b32 v23, v22 offset:144
  v_mfma_f32_16x16x32_bf16 v[48:51], v[72:75], v[148:151], v[48:51]
  v_mfma_f32_16x16x32_bf16 v[52:55], v[120:123], v[148:151], v[52:55]
  v_mfma_f32_16x16x32_bf16 v[44:47], v[144:147], v[132:135], v[44:47]
  v_mfma_f32_16x16x32_bf16 v[48:51], v[144:147], v[76:79], v[48:51]
  v_mfma_f32_16x16x32_bf16 v[52:55], v[144:147], v[124:127], v[52:55]
  s_waitcnt lgkmcnt(0)
  v_cmp_ne_u32 vcc, 0, v23
  s_cbranch_vccnz SL_282
SD_283:
  v_mfma_f32_16x16x32_bf16 v[48:51], v[128:131], v[60:63], v[48:51]
  ds_read_b32 v23, v22 offset:144
  v_mfma_f32_16x16x32_bf16 v[52:55], v[72:75], v[60:63], v[52:55]
  v_mfma_f32_16x16x32_bf16 v[48:51], v[56:59], v[132:135], v[48:51]
  v_mfma_f32_16x16x32_bf16 v[52:55], v[56:59], v[76:79], v[52:55]
  v_mfma_f32_16x16x32_bf16 v[52:55], v[128:131], v[84:87], v[52:55]
  v_mfma_f32_16x16x32_bf16 v[52:55], v[80:83], v[132:135], v[52:55]
  s_setprio 1
  ds_write_b32 v22, v2 offset:176
  s_waitcnt lgkmcnt(0)
  v_lshlrev_b32 v56, 16, v152
  v_and_b32 v57, 0xffff0000, v152
  v_lshlrev_b32 v58, 16, v153
  v_and_b32 v59, 0xffff0000, v153
  v_lshlrev_b32 v60, 16, v154
  v_and_b32 v61, 0xffff0000, v154
  v_lshlrev_b32 v62, 16, v155
  v_and_b32 v63, 0xffff0000, v155
  v_lshlrev_b32 v64, 16, v156
  v_and_b32 v65, 0xffff0000, v156
  v_lshlrev_b32 v66, 16, v157
  v_and_b32 v67, 0xffff0000, v157
  v_lshlrev_b32 v68, 16, v158
  v_and_b32 v69, 0xffff0000, v158
  v_lshlrev_b32 v70, 16, v159
  v_and_b32 v71, 0xffff0000, v159
  v_mul_f32 v56, s70, v56
  v_mul_f32 v57, s70, v57
  v_mul_f32 v58, s70, v58
  v_mul_f32 v59, s70, v59
  v_mul_f32 v60, s70, v60
  v_mul_f32 v61, s70, v61
  v_mul_f32 v62, s70, v62
  v_mul_f32 v63, s70, v63
  v_mul_f32 v64, s70, v64
  v_mul_f32 v65, s70, v65
  v_mul_f32 v66, s70, v66
  v_mul_f32 v67, s70, v67
  v_mul_f32 v68, s70, v68
  v_mul_f32 v69, s70, v69
  v_mul_f32 v70, s70, v70
  v_mul_f32 v71, s70, v71
  v_cvt_pk_bf16_f32 v152, v56, v57
  v_cvt_pk_bf16_f32 v153, v58, v59
  v_cvt_pk_bf16_f32 v154, v60, v61
  v_cvt_pk_bf16_f32 v155, v62, v63
  v_cvt_pk_bf16_f32 v156, v64, v65
  v_cvt_pk_bf16_f32 v157, v66, v67
  v_cvt_pk_bf16_f32 v158, v68, v69
  v_cvt_pk_bf16_f32 v159, v70, v71
  s_cmp_eq_u32 s12, 0
  s_cbranch_scc1 B_sw
  v_swap_b32 v24, v40
  v_swap_b32 v25, v41
  v_swap_b32 v26, v42
  v_swap_b32 v27, v43
  v_swap_b32 v28, v44
  v_swap_b32 v29, v45
  v_swap_b32 v30, v46
  v_swap_b32 v31, v47
  v_swap_b32 v32, v48
  v_swap_b32 v33, v49
  v_swap_b32 v34, v50
  v_swap_b32 v35, v51
  v_swap_b32 v36, v52
  v_swap_b32 v37, v53
  v_swap_b32 v38, v54
  v_swap_b32 v39, v55
B_sw:
SL_285:
  ds_read_b32 v11, v14 offset:176
  s_waitcnt lgkmcnt(0)
  v_cmp_gt_u32 vcc, 1, v11
  s_cbranch_vccz SD_286
  s_sub_u32 s68, s68, 1
  s_cbranch_scc0 SL_285
  s_mov_b32 s68, 0
SD_286:
  ds_write_b128 v12, v[40:43] offset:0
  ds_write_b128 v12, v[44:47] offset:1024
  ds_write_b128 v12, v[48:51] offset:2048
  ds_write_b128 v12, v[52:55] offset:3072
  v_mov_b32 v11, 2
  ds_write_b32 v22, v11 offset:176
  s_mov_b64 exec, 1
  ds_add_u32 v1, v2 offset:92
  s_mov_b64 exec, -1
  v_lshlrev_b32 v56, 16, v152
  v_and_b32 v57, 0xffff0000, v152
  v_lshlrev_b32 v58, 16, v153
  v_and_b32 v59, 0xffff0000, v153
  v_lshlrev_b32 v60, 16, v154
  v_and_b32 v61, 0xffff0000, v154
  v_lshlrev_b32 v62, 16, v155
  v_and_b32 v63, 0xffff0000, v155
  v_lshlrev_b32 v64, 16, v156
  v_and_b32 v65, 0xffff0000, v156
  v_lshlrev_b32 v66, 16, v157
  v_and_b32 v67, 0xffff0000, v157
  v_lshlrev_b32 v68, 16, v158
  v_and_b32 v69, 0xffff0000, v158
  v_lshlrev_b32_e64 v70, 16, v159
  v_and_b32 v71, 0xffff0000, v159
SL_288:
  ds_read_b32 v11, v14 offset:176
  ds_read_b128 v[88:91], v13 offset:0
  ds_read_b128 v[92:95], v13 offset:1024
  ds_read_b128 v[96:99], v13 offset:2048
  ds_read_b128 v[100:103], v13 offset:3072
  s_waitcnt lgkmcnt(0)
  v_cmp_gt_u32 vcc, 2, v11
  s_cbranch_vccz SD_289
  s_sub_u32 s68, s68, 1
  s_cbranch_scc0 SL_288
  s_mov_b32 s68, 0
SD_289:
  v_add_f32 v24, v24, v88
  v_add_f32 v25, v25, v89
  v_add_f32 v26, v26, v90
  v_add_f32 v27, v27, v91
  v_add_f32 v28, v28, v92
  v_add_f32 v29, v29, v93
  v_add_f32 v30, v30, v94
  v_add_f32 v31, v31, v95
  v_add_f32 v32, v32, v96
  v_add_f32 v33, v33, v97
  v_add_f32 v34, v34, v98
  v_add_f32 v35, v35, v99
  v_add_f32 v36, v36, v100
  v_add_f32 v37, v37, v101
  v_add_f32 v38, v38, v102
  v_add_f32 v39, v39, v103
  v_cvt_pk_bf16_f32 v152, v24, v25
  v_cvt_pk_bf16_f32 v153, v26, v27
  v_cvt_pk_bf16_f32 v154, v28, v29
  v_cvt_pk_bf16_f32 v155, v30, v31
  v_cvt_pk_bf16_f32 v156, v32, v33
  v_cvt_pk_bf16_f32 v157, v34, v35
  v_cvt_pk_bf16_f32 v158, v36, v37
  v_cvt_pk_bf16_f32 v159, v38, v39
  v_lshlrev_b32 v24, 16, v152
  v_and_b32 v25, 0xffff0000, v152
  v_lshlrev_b32 v26, 16, v153
  v_and_b32 v27, 0xffff0000, v153
  v_lshlrev_b32 v28, 16, v154
  v_and_b32 v29, 0xffff0000, v154
  v_lshlrev_b32 v30, 16, v155
  v_and_b32 v31, 0xffff0000, v155
  v_lshlrev_b32 v32, 16, v156
  v_and_b32 v33, 0xffff0000, v156
  v_lshlrev_b32 v34, 16, v157
  v_and_b32 v35, 0xffff0000, v157
  v_lshlrev_b32 v36, 16, v158
  v_and_b32 v37, 0xffff0000, v158
  v_lshlrev_b32 v38, 16, v159
  v_and_b32 v39, 0xffff0000, v159
  v_add_f32 v56, v56, v24
  v_add_f32 v57, v57, v25
  v_add_f32 v58, v58, v26
  v_add_f32 v59, v59, v27
  v_add_f32 v60, v60, v28
  v_add_f32 v61, v61, v29
  v_add_f32 v62, v62, v30
  v_add_f32 v63, v63, v31
  v_add_f32 v64, v64, v32
  v_add_f32 v65, v65, v33
  v_add_f32 v66, v66, v34
  v_add_f32 v67, v67, v35
  v_add_f32 v68, v68, v36
  v_add_f32 v69, v69, v37
  v_add_f32 v70, v70, v38
  v_add_f32 v71, v71, v39
  v_cvt_pk_bf16_f32 v72, v56, v57
  v_cvt_pk_bf16_f32 v73, v58, v59
  v_mov_b32 v74, s7
  buffer_store_dwordx4 v[72:75], v10, s[52:55], s73 offen offset:0 sc1
  v_cvt_pk_bf16_f32 v76, v60, v61
  v_cvt_pk_bf16_f32 v77, v62, v63
  v_mov_b32 v78, s7
  buffer_store_dwordx4 v[76:79], v10, s[52:55], s73 offen offset:1024 sc1
  v_cvt_pk_bf16_f32 v80, v64, v65
  v_cvt_pk_bf16_f32 v81, v66, v67
  v_mov_b32 v82, s7
  buffer_store_dwordx4 v[80:83], v10, s[52:55], s73 offen offset:2048 sc1
  v_cvt_pk_bf16_f32 v84, v68, v69
  v_cvt_pk_bf16_f32 v85, v70, v71
  v_mov_b32 v86, s7
  buffer_store_dwordx4 v[84:87], v10, s[52:55], s73 offen offset:3072 sc1
  v_lshrrev_b32 v8, 3, v0
  v_and_b32 v9, 7, v0
  v_lshlrev_b32 v10, 6, v8
  v_lshl_add_u32 v10, v9, 3, v10
  s_lshl_b32 s72, s10, 11
  s_add_u32 s72, s72, 114688
  v_add_u32 v10, s72, v10
  v_lshlrev_b32 v8, 13, v8
  v_lshl_add_u32 v8, v9, 4, v8
  s_lshl1_add_u32 s72, s5, s12
  s_lshl_b32 s72, s72, 18
  s_lshl1_add_u32 s73, s4, s11
  s_lshl_b32 s73, s73, 7
  s_add_u32 s72, s72, s73
  s_add_u32 s72, s72, 20971520
  s_add_u32 s73, s72, 0x10000
  s_add_u32 s74, s72, 0x20000
  s_add_u32 s75, s72, 0x30000
  s_add_u32 s15, s15, 4
SL_291:
  ds_read_b32 v11, v1 offset:92
  s_waitcnt lgkmcnt(0)
  v_cmp_gt_u32 vcc, s15, v11
  s_cbranch_vccz SD_292
  s_sleep 1
  s_sub_u32 s68, s68, 1
  s_cbranch_scc0 SL_291
  s_mov_b32 s68, 0
SD_292:
  s_cmp_eq_u32 s2, 255
  s_cbranch_scc0 B_noep
  s_cmp_eq_u32 s10, 0
  s_cbranch_scc0 B_noep
  v_lshrrev_b32 v12, 2, v0
  v_mul_u32_u24 v12, 649216, v12
  v_and_b32 v13, 3, v0
  v_lshl_add_u32 v12, v13, 4, v12
  s_mov_b32 s70, 319488
SL_294:
  buffer_load_dwordx4 v[104:107], v12, s[52:55], s70 offen sc1
  s_waitcnt vmcnt(0)
  v_xor_b32 v104, s7, v104
  v_xor_b32 v105, s7, v105
  v_xor_b32 v106, s7, v106
  v_xor_b32 v107, s7, v107
  v_or3_b32 v11, v104, v105, v106
  v_or_b32 v11, v11, v107
  v_cmp_lt_u32 vcc, 7, v11
  s_cbranch_vccz SD_295
  s_sleep 8
  s_sub_u32 s68, s68, 1
  s_cbranch_scc0 SL_294
  s_mov_b32 s68, 0
SD_295:
  v_mov_b32 v11, s7
  s_mov_b32 s70, 19931136
  buffer_store_dword v11, off, s[52:55], s70 sc1
B_noep:
SL_297:
  ds_read_b32 v11, v1 offset:108
  s_waitcnt lgkmcnt(0)
  v_cmp_gt_u32 vcc, 16, v11
  s_cbranch_vccz SD_298
  s_sleep 8
  s_sub_u32 s68, s68, 1
  s_cbranch_scc0 SL_297
  s_mov_b32 s68, 0
SD_298:
SL_300:
  buffer_load_dwordx4 v[104:107], v8, s[52:55], s72 offen sc1
  buffer_load_dwordx4 v[108:111], v8, s[52:55], s73 offen sc1
  buffer_load_dwordx4 v[112:115], v8, s[52:55], s74 offen sc1
  buffer_load_dwordx4 v[116:119], v8, s[52:55], s75 offen sc1
  s_waitcnt vmcnt(0)
  v_xor_b32 v106, s7, v106
  v_xor_b32 v110, s7, v110
  v_xor_b32 v114, s7, v114
  v_xor_b32 v118, s7, v118
  v_or3_b32 v11, v106, v110, v114
  v_or_b32 v11, v11, v118
  v_cmp_ne_u32 vcc, 0, v11
  s_cbranch_vccz SD_301
  s_sleep 8
  s_sub_u32 s68, s68, 1
  s_cbranch_scc0 SL_300
  s_mov_b32 s68, 0
SD_301:
  ds_write_b64 v10, v[104:105] offset:0
  ds_write_b64 v10, v[108:109] offset:512
  ds_write_b64 v10, v[112:113] offset:1024
  ds_write_b64 v10, v[116:117] offset:1536
  ds_write_b32 v22, v2 offset:48
  s_waitcnt lgkmcnt(0)
  s_endpgm
B_xretry:
  s_sub_u32 s68, s68, 1
  s_cbranch_scc1 B_xgive
  s_bitcmp1_b32 s68, 3
  s_cbranch_scc0 B_xvec
  s_load_dwordx16 s[16:31], s[48:49], s50 glc
  s_waitcnt lgkmcnt(0)
  s_branch B_xchk
B_xvec:
  v_lshlrev_b32 v10, 2, v0
  buffer_load_dword v11, v10, s[52:55], s50 offen sc1
  s_waitcnt vmcnt(0)
  v_readlane_b32 s16, v11, 0
  v_readlane_b32 s17, v11, 1
  v_readlane_b32 s18, v11, 2
  v_readlane_b32 s19, v11, 3
  v_readlane_b32 s20, v11, 4
  v_readlane_b32 s21, v11, 5
  v_readlane_b32 s22, v11, 6
  v_readlane_b32 s23, v11, 7
  v_readlane_b32 s24, v11, 8
  v_readlane_b32 s25, v11, 9
  v_readlane_b32 s26, v11, 10
  v_readlane_b32 s27, v11, 11
  v_readlane_b32 s28, v11, 12
  v_readlane_b32 s29, v11, 13
  v_readlane_b32 s30, v11, 14
  v_readlane_b32 s31, v11, 15
  s_branch B_xchk
B_xgive:
  s_mov_b32 s68, 0
  s_branch B_xok
ST_209:
  s_mov_b32 s68, 0
  s_branch SD_208
SL_216:
  s_sub_u32 s68, s68, 1
  s_cbranch_scc1 ST_218
  s_sleep 1
  ds_read_b32 v23, v22 offset:144
  s_waitcnt lgkmcnt(0)
  v_cmp_ne_u32 vcc, 0, v23
  s_cbranch_vccnz SL_216
  s_branch SD_217
ST_218:
  s_mov_b32 s68, 0
  s_branch SD_217
SL_219:
  s_sub_u32 s68, s68, 1
  s_cbranch_scc1 ST_221
  s_sleep 1
  ds_read_b32 v23, v22 offset:144
  s_waitcnt lgkmcnt(0)
  v_cmp_ne_u32 vcc, 0, v23
  s_cbranch_vccnz SL_219
  s_branch SD_220
ST_221:
  s_mov_b32 s68, 0
  s_branch SD_220
SL_222:
  s_sub_u32 s68, s68, 1
  s_cbranch_scc1 ST_224
  s_sleep 1
  ds_read_b32 v23, v22 offset:144
  s_waitcnt lgkmcnt(0)
  v_cmp_ne_u32 vcc, 0, v23
  s_cbranch_vccnz SL_222
  s_branch SD_223
ST_224:
  s_mov_b32 s68, 0
  s_branch SD_223
SL_225:
  s_sub_u32 s68, s68, 1
  s_cbranch_scc1 ST_227
  s_sleep 1
  ds_read_b32 v23, v22 offset:144
  s_waitcnt lgkmcnt(0)
  v_cmp_ne_u32 vcc, 0, v23
  s_cbranch_vccnz SL_225
  s_branch SD_226
ST_227:
  s_mov_b32 s68, 0
  s_branch SD_226
SL_228:
  s_sub_u32 s68, s68, 1
  s_cbranch_scc1 ST_230
  s_sleep 1
  ds_read_b32 v23, v22 offset:144
  s_waitcnt lgkmcnt(0)
  v_cmp_ne_u32 vcc, 0, v23
  s_cbranch_vccnz SL_228
  s_branch SD_229
ST_230:
  s_mov_b32 s68, 0
  s_branch SD_229
SL_231:
  s_sub_u32 s68, s68, 1
  s_cbranch_scc1 ST_233
  s_sleep 1
  ds_read_b32 v23, v22 offset:144
  s_waitcnt lgkmcnt(0)
  v_cmp_ne_u32 vcc, 0, v23
  s_cbranch_vccnz SL_231
  s_branch SD_232
ST_233:
  s_mov_b32 s68, 0
  s_branch SD_232
SL_234:
  s_sub_u32 s68, s68, 1
  s_cbranch_scc1 ST_236
  s_sleep 1
  ds_read_b32 v23, v22 offset:144
  s_waitcnt lgkmcnt(0)
  v_cmp_ne_u32 vcc, 0, v23
  s_cbranch_vccnz SL_234
  s_branch SD_235
ST_236:
  s_mov_b32 s68, 0
  s_branch SD_235
SL_237:
  s_sub_u32 s68, s68, 1
  s_cbranch_scc1 ST_239
  s_sleep 1
  ds_read_b32 v23, v22 offset:144
  s_waitcnt lgkmcnt(0)
  v_cmp_ne_u32 vcc, 0, v23
  s_cbranch_vccnz SL_237
  s_branch SD_238
ST_239:
  s_mov_b32 s68, 0
  s_branch SD_238
SL_240:
  s_sub_u32 s68, s68, 1
  s_cbranch_scc1 ST_242
  s_sleep 1
  ds_read_b32 v23, v22 offset:144
  s_waitcnt lgkmcnt(0)
  v_cmp_ne_u32 vcc, 0, v23
  s_cbranch_vccnz SL_240
  s_branch SD_241
ST_242:
  s_mov_b32 s68, 0
  s_branch SD_241
SL_243:
  s_sub_u32 s68, s68, 1
  s_cbranch_scc1 ST_245
  s_sleep 1
  ds_read_b32 v23, v22 offset:144
  s_waitcnt lgkmcnt(0)
  v_cmp_ne_u32 vcc, 0, v23
  s_cbranch_vccnz SL_243
  s_branch SD_244
ST_245:
  s_mov_b32 s68, 0
  s_branch SD_244
SL_246:
  s_sub_u32 s68, s68, 1
  s_cbranch_scc1 ST_248
  s_sleep 1
  ds_read_b32 v23, v22 offset:144
  s_waitcnt lgkmcnt(0)
  v_cmp_ne_u32 vcc, 0, v23
  s_cbranch_vccnz SL_246
  s_branch SD_247
ST_248:
  s_mov_b32 s68, 0
  s_branch SD_247
SL_249:
  s_sub_u32 s68, s68, 1
  s_cbranch_scc1 ST_251
  s_sleep 1
  ds_read_b32 v23, v22 offset:144
  s_waitcnt lgkmcnt(0)
  v_cmp_ne_u32 vcc, 0, v23
  s_cbranch_vccnz SL_249
  s_branch SD_250
ST_251:
  s_mov_b32 s68, 0
  s_branch SD_250
SL_252:
  s_sub_u32 s68, s68, 1
  s_cbranch_scc1 ST_254
  s_sleep 1
  ds_read_b32 v23, v22 offset:144
  s_waitcnt lgkmcnt(0)
  v_cmp_ne_u32 vcc, 0, v23
  s_cbranch_vccnz SL_252
  s_branch SD_253
ST_254:
  s_mov_b32 s68, 0
  s_branch SD_253
SL_255:
  s_sub_u32 s68, s68, 1
  s_cbranch_scc1 ST_257
  s_sleep 1
  ds_read_b32 v23, v22 offset:144
  s_waitcnt lgkmcnt(0)
  v_cmp_ne_u32 vcc, 0, v23
  s_cbranch_vccnz SL_255
  s_branch SD_256
ST_257:
  s_mov_b32 s68, 0
  s_branch SD_256
SL_258:
  s_sub_u32 s68, s68, 1
  s_cbranch_scc1 ST_260
  s_sleep 1
  ds_read_b32 v23, v22 offset:144
  s_waitcnt lgkmcnt(0)
  v_cmp_ne_u32 vcc, 0, v23
  s_cbranch_vccnz SL_258
  s_branch SD_259
ST_260:
  s_mov_b32 s68, 0
  s_branch SD_259
SL_261:
  s_sub_u32 s68, s68, 1
  s_cbranch_scc1 ST_263
  s_sleep 1
  ds_read_b32 v23, v22 offset:144
  s_waitcnt lgkmcnt(0)
  v_cmp_ne_u32 vcc, 0, v23
  s_cbranch_vccnz SL_261
  s_branch SD_262
ST_263:
  s_mov_b32 s68, 0
  s_branch SD_262
SL_264:
  s_sub_u32 s68, s68, 1
  s_cbranch_scc1 ST_266
  s_sleep 1
  ds_read_b32 v23, v22 offset:144
  s_waitcnt lgkmcnt(0)
  v_cmp_ne_u32 vcc, 0, v23
  s_cbranch_vccnz SL_264
  s_branch SD_265
ST_266:
  s_mov_b32 s68, 0
  s_branch SD_265
SL_267:
  s_sub_u32 s68, s68, 1
  s_cbranch_scc1 ST_269
  s_sleep 1
  ds_read_b32 v23, v22 offset:144
  s_waitcnt lgkmcnt(0)
  v_cmp_ne_u32 vcc, 0, v23
  s_cbranch_vccnz SL_267
  s_branch SD_268
ST_269:
  s_mov_b32 s68, 0
  s_branch SD_268
SL_270:
  s_sub_u32 s68, s68, 1
  s_cbranch_scc1 ST_272
  s_sleep 1
  ds_read_b32 v23, v22 offset:144
  s_waitcnt lgkmcnt(0)
  v_cmp_ne_u32 vcc, 0, v23
  s_cbranch_vccnz SL_270
  s_branch SD_271
ST_272:
  s_mov_b32 s68, 0
  s_branch SD_271
SL_273:
  s_sub_u32 s68, s68, 1
  s_cbranch_scc1 ST_275
  s_sleep 1
  ds_read_b32 v23, v22 offset:144
  s_waitcnt lgkmcnt(0)
  v_cmp_ne_u32 vcc, 0, v23
  s_cbranch_vccnz SL_273
  s_branch SD_274
ST_275:
  s_mov_b32 s68, 0
  s_branch SD_274
SL_276:
  s_sub_u32 s68, s68, 1
  s_cbranch_scc1 ST_278
  s_sleep 1
  ds_read_b32 v23, v22 offset:144
  s_waitcnt lgkmcnt(0)
  v_cmp_ne_u32 vcc, 0, v23
  s_cbranch_vccnz SL_276
  s_branch SD_277
ST_278:
  s_mov_b32 s68, 0
  s_branch SD_277
SL_279:
  s_sub_u32 s68, s68, 1
  s_cbranch_scc1 ST_281
  s_sleep 1
  ds_read_b32 v23, v22 offset:144
  s_waitcnt lgkmcnt(0)
  v_cmp_ne_u32 vcc, 0, v23
  s_cbranch_vccnz SL_279
  s_branch SD_280
ST_281:
  s_mov_b32 s68, 0
  s_branch SD_280
SL_282:
  s_sub_u32 s68, s68, 1
  s_cbranch_scc1 ST_284
  s_sleep 1
  ds_read_b32 v23, v22 offset:144
  s_waitcnt lgkmcnt(0)
  v_cmp_ne_u32 vcc, 0, v23
  s_cbranch_vccnz SL_282
  s_branch SD_283
ST_284:
  s_mov_b32 s68, 0
  s_branch SD_283
K_end:
.section .rodata,"a"
.p2align 6
.amdhsa_kernel recurrent_scan__ssm_conv_s4__mixer_s_mlp__prompt_kernel
  .amdhsa_next_free_vgpr 168
  .amdhsa_next_free_sgpr 102
  .amdhsa_accum_offset 168
  .amdhsa_group_segment_fixed_size 0
  .amdhsa_kernarg_size 136
  .amdhsa_user_sgpr_count 2
  .amdhsa_user_sgpr_kernarg_segment_ptr 1
  .amdhsa_system_sgpr_workgroup_id_x 1
.end_amdhsa_kernel
```
